```python
import torch

def _softmax(x, axis=-1):
    return torch.softmax(x, dim=axis)

def _gelu(x):
    return torch.nn.functional.gelu(x, approximate='tanh')

def _silu(x):
    return torch.nn.functional.silu(x)

def _sigmoid(x):
    return torch.sigmoid(x)

def _layernorm(x, axis=-1, eps=1e-05):
    m = x.mean(dim=axis, keepdim=True)
    v = x.var(dim=axis, keepdim=True, unbiased=False)
    return (x - m) / torch.sqrt(v + eps)

def _scatter_add(tgt, idx, src, axis=0):
    return tgt.clone().index_add_(axis, idx, src)

def _segment_sum(src, seg, n):
    out = torch.zeros((n,) + src.shape[1:], dtype=src.dtype)
    return out.index_add_(0, seg, src)

def _pad(x, pw):
    flat = tuple((v for pair in reversed(pw) for v in pair))
    return torch.nn.functional.pad(x, flat)
kernel_name = 'sequential_preLN__ssm_conv_h3__mixer_gmlp__prompt'

def setup_inputs():

    _w = lambda a: (lambda t: t.to(torch.bfloat16) if t.is_floating_point() else t)(torch.as_tensor(a))

    def _A_setup():
        B, S, D = (1, 2048, 512)
        ks = 4
        return {'q': _w((lambda *s: torch.randn(*s, dtype=torch.bfloat16) * 0.05)(B, S, D)), 'k': _w((lambda *s: torch.randn(*s, dtype=torch.bfloat16) * 0.4)(B, S, D)), 'v': _w((lambda *s: torch.randn(*s, dtype=torch.bfloat16) * 0.4)(B, S, D)), 'shift_k': _w((lambda *s: torch.randn(*s, dtype=torch.bfloat16) * 0.4)(D, ks) * 0.5), 'ssm_k': _w((lambda *s: torch.randn(*s, dtype=torch.bfloat16) * 0.4)(D, S) * (1.0 / S ** 0.5)), 'ssm_D': _w((lambda *s: torch.randn(*s, dtype=torch.bfloat16) * 0.4)(D))}
    _A_in = _A_setup()

    def _B_setup():
        B, S, D, F = (1, 2048, 512, 1792)
        Fh = F // 2
        return {'x': _w((lambda *s: torch.randn(*s, dtype=torch.bfloat16) * 0.05)(B, S, D)), 'w_in': _w((lambda *s: torch.randn(*s, dtype=torch.bfloat16) * 0.4)(D, 2 * Fh)), 'w_sp': _w(0.01 * (lambda *s: torch.randn(*s, dtype=torch.bfloat16) * 0.4)(S, S)), 'b_sp': _w(1.0 + 0.01 * (lambda *s: torch.randn(*s, dtype=torch.bfloat16) * 0.05)(S)), 'w_out': _w((lambda *s: torch.randn(*s, dtype=torch.bfloat16) * 0.05)(Fh, D))}
    _B_in = _B_setup()
    return {'A_q': _A_in['q'], 'A_k': _A_in['k'], 'A_v': _A_in['v'], 'A_shift_k': _A_in['shift_k'], 'A_ssm_k': _A_in['ssm_k'], 'A_ssm_D': _A_in['ssm_D'], 'B_x': _B_in['x'], 'B_w_in': _B_in['w_in'], 'B_w_sp': _B_in['w_sp'], 'B_b_sp': _B_in['b_sp'], 'B_w_out': _B_in['w_out']}

def reference(A_q, A_k, A_v, A_shift_k, A_ssm_k, A_ssm_D, B_x, B_w_in, B_w_sp, B_b_sp, B_w_out):

    def _A_ref(q, k, v, shift_k, ssm_k, ssm_D):
        B, S, D = q.shape
        ks = shift_k.shape[-1]
        k_pad = _pad(k, ((0, 0), (ks - 1, 0), (0, 0)))
        k_shift = torch.zeros_like(k)
        for t in range(ks):
            k_shift = k_shift + k_pad[:, t:t + S, :] * shift_k[:, ks - 1 - t][None, None, :]
        kv = k_shift * v
        L = 2 * S
        kv_pad = _pad(kv, ((0, 0), (0, S), (0, 0)))
        kf_pad = _pad(ssm_k, ((0, 0), (0, S)))
        kv_f = (lambda x, axes=(-2, -1): torch.fft.rfft2(x.float(), dim=axes))(kv_pad[:, None, :, :], axes=(1, 2))
        kf_f = (lambda x, axes=(-2, -1): torch.fft.rfft2(x.float(), dim=axes))(kf_pad[:, None, :], axes=(1, 2))
        kf_f = (lambda x, *d: x.permute(*d))(kf_f, 1, 2, 0)
        y_f = kv_f * kf_f[None, :, :, :]
        y = (lambda x, s, axes=(-2, -1): torch.fft.irfft2(x, s=s, dim=axes).to(torch.bfloat16))(y_f, (1, L), axes=(1, 2))[:, 0, :S, :]
        y = y + kv * ssm_D[None, None, :]
        return q * y

    def _B_ref(x, w_in, w_sp, b_sp, w_out):
        B, S, D = x.shape
        F = w_in.shape[-1]
        Fh = F // 2
        z = _gelu(torch.einsum('bsd,df->bsf', x, w_in))
        z1 = z[..., :Fh].clone()
        z2 = _layernorm(z[..., Fh:], axis=-1)
        g = torch.einsum('ts,bsf->btf', w_sp, z2) + b_sp[None, :, None]
        return torch.einsum('bsf,fd->bsd', z1 * g, w_out)
    x = A_q
    h = x + _A_ref(_layernorm(x, axis=-1), A_k, A_v, A_shift_k, A_ssm_k, A_ssm_D)
    h2 = h + _B_ref(_layernorm(h, axis=-1), B_w_in, B_w_sp, B_b_sp, B_w_out)
    return h2
```

```asm
; @launch kernel=ka_kernel grid=(256,1,1) block=(256,1,1) lds=72192
; @launch kernel=kb_kernel grid=(256,1,1) block=(256,1,1) lds=159744
.amdgcn_target "amdgcn-amd-amdhsa--gfx950"
.text
.globl ka_kernel
.p2align 8
.type ka_kernel,@function
ka_kernel:
    s_cmp_ge_u32 s2, 256
    s_cbranch_scc1 KA_END
    s_load_dwordx4 s[4:7], s[0:1], 0
    s_load_dwordx4 s[8:11], s[0:1], 16
    s_load_dwordx2 s[12:13], s[0:1], 104
    s_load_dwordx4 s[40:43], s[0:1], 32
    s_load_dwordx2 s[44:45], s[0:1], 96
    v_lshrrev_b32 v1, 6, v0
    s_nop 0
    v_readfirstlane_b32 s50, v1
    v_and_b32 v2, 63, v0
    v_and_b32 v3, 31, v0
    v_lshrrev_b32 v4, 5, v0
    s_and_b32 s14, s2, 7
    s_lshr_b32 s3, s2, 3
    s_mov_b32 s60, 0x05040100
    s_mov_b32 s61, 0x07060302
    s_mov_b32 s62, 0x3f803f80
    s_lshl_b32 s15, s3, 16
    s_lshl_b32 s48, s14, 7
    s_add_u32 s15, s15, s48
    v_lshlrev_b32 v9, 13, v4
    v_lshlrev_b32 v10, 2, v3
    v_add3_u32 v5, v9, v10, s15
    v_subrev_u32 v6, 3072, v5
    s_lshl_b32 s49, s14, 9
    v_lshlrev_b32 v7, 4, v3
    v_add_u32 v7, s49, v7
    s_lshl_b32 s51, s2, 3
    s_lshl_b32 s52, s50, 1
    s_add_u32 s51, s51, s52
    s_lshl_b32 s52, s51, 10
    v_lshlrev_b32 v8, 4, v2
    v_add_u32 v8, s52, v8
    s_mov_b32 s53, 4096
    s_waitcnt lgkmcnt(0)
    s_mov_b32 s16, s4
    s_mov_b32 s17, s5
    s_mov_b32 s18, 2097152
    s_mov_b32 s19, 0x00020000
    s_mov_b32 s20, s6
    s_mov_b32 s21, s7
    s_mov_b32 s22, 2097152
    s_mov_b32 s23, 0x00020000
    s_mov_b32 s24, s8
    s_mov_b32 s25, s9
    s_mov_b32 s26, 2097152
    s_mov_b32 s27, 0x00020000
    s_mov_b32 s28, s10
    s_mov_b32 s29, s11
    s_mov_b32 s30, 4096
    s_mov_b32 s31, 0x00020000
    buffer_load_dword v110, v6, s[20:23], 0 offen offset:0
    buffer_load_dword v111, v6, s[20:23], 0 offen offset:1024
    buffer_load_dword v112, v6, s[20:23], 0 offen offset:2048
    buffer_load_dword v113, v5, s[20:23], 0 offen offset:0
    buffer_load_dword v114, v5, s[20:23], 0 offen offset:1024
    buffer_load_dword v115, v5, s[20:23], 0 offen offset:2048
    buffer_load_dword v116, v5, s[20:23], 0 offen offset:3072
    buffer_load_dword v117, v5, s[20:23], s53 offen offset:0
    buffer_load_dword v118, v5, s[20:23], s53 offen offset:1024
    buffer_load_dword v119, v5, s[20:23], s53 offen offset:2048
    buffer_load_dword v120, v5, s[20:23], s53 offen offset:3072
    buffer_load_dwordx4 v[140:143], v7, s[28:31], 0 offen
    buffer_load_dword v121, v5, s[24:27], 0 offen offset:0
    buffer_load_dword v122, v5, s[24:27], 0 offen offset:1024
    buffer_load_dword v123, v5, s[24:27], 0 offen offset:2048
    buffer_load_dword v124, v5, s[24:27], 0 offen offset:3072
    buffer_load_dword v125, v5, s[24:27], s53 offen offset:0
    buffer_load_dword v126, v5, s[24:27], s53 offen offset:1024
    buffer_load_dword v127, v5, s[24:27], s53 offen offset:2048
    buffer_load_dword v128, v5, s[24:27], s53 offen offset:3072
    buffer_load_dword v129, v5, s[16:19], 0 offen offset:0
    buffer_load_dword v130, v5, s[16:19], 0 offen offset:1024
    buffer_load_dword v131, v5, s[16:19], 0 offen offset:2048
    buffer_load_dword v132, v5, s[16:19], 0 offen offset:3072
    buffer_load_dword v133, v5, s[16:19], s53 offen offset:0
    buffer_load_dword v134, v5, s[16:19], s53 offen offset:1024
    buffer_load_dword v135, v5, s[16:19], s53 offen offset:2048
    buffer_load_dword v136, v5, s[16:19], s53 offen offset:3072
    buffer_load_dwordx4 v[144:147], v8, s[16:19], 0 offen
    buffer_load_dwordx4 v[148:151], v8, s[16:19], 0 offen offset:1024
    s_mov_b32 s64, s44
    s_mov_b32 s65, s45
    s_mov_b32 s66, 256
    s_mov_b32 s67, 0x00020000
    s_cmp_eq_u32 s2, 0
    s_cbranch_scc0 KA_NOPUB
    s_cmp_eq_u32 s50, 0
    s_cbranch_scc0 KA_NOPUB
    s_memrealtime s[68:69]
    s_waitcnt lgkmcnt(0)
    s_or_b32 s68, s68, 1
    v_mov_b32 v11, s68
    v_cmp_eq_u32 vcc, 0, v2
    v_mov_b32 v12, 0
    v_mov_b32 v13, 0x7fffffff
    v_cndmask_b32 v12, v13, v12, vcc
    buffer_store_dword v11, v12, s[64:67], 0 offen sc0 sc1
KA_NOPUB:
    s_cmp_eq_u32 s50, 3
    s_cbranch_scc0 KA_NOT
    s_mov_b32 s77, 0
    s_getpc_b64 s[78:79]
KAT_PC:
    s_sub_u32 s78, s78, KAT_PC-ka_kernel
    s_subb_u32 s79, s79, 0
    s_lshl_b32 s80, s77, 13
    v_lshlrev_b32 v56, 7, v2
    v_add_u32 v56, s80, v56
    s_mov_b32 s80, KA_CODE_END-ka_kernel-4
    v_min_u32 v56, s80, v56
    global_load_dword v57, v56, s[78:79]
    s_cmp_lt_u32 s3, 5
    s_cbranch_scc0 KA_NOT
    s_mov_b32 s77, s3
    s_getpc_b64 s[78:79]
KAU_PC:
    s_add_u32 s78, s78, kb_kernel-KAU_PC
    s_addc_u32 s79, s79, 0
    s_lshl_b32 s80, s77, 13
    v_lshlrev_b32 v58, 7, v2
    v_add_u32 v58, s80, v58
    s_mov_b32 s80, KB_CODE_END-kb_kernel-4
    v_min_u32 v58, s80, v58
    global_load_dword v59, v58, s[78:79]
KA_NOT:
    s_lshr_b32 s54, s50, 1
    s_and_b32 s55, s50, 1
    s_lshl_b32 s56, s14, 6
    s_lshl_b32 s57, s3, 1
    s_add_u32 s56, s56, s57
    s_add_u32 s56, s56, s54
    s_lshl_b32 s57, s56, 12
    s_mul_i32 s58, s56, 4224
    s_mul_i32 s59, s54, 27136
    s_add_u32 s32, s40, s57
    s_addc_u32 s33, s41, 0
    s_mov_b32 s34, 4096
    s_mov_b32 s35, 0x00020000
    s_lshl_b32 s63, s55, 6
    v_add_u32 v25, s63, v2
    s_mov_b32 s70, -54
    s_mov_b32 s71, -4158
    s_lshl_b32 s72, s55, 10
    s_add_u32 s72, s72, s59
    v_add_u32 v26, 0, v25
    v_mul_u32_u24 v27, 1009, v26
    v_lshrrev_b32 v27, 18, v27
    v_lshl_add_u32 v26, v26, 4, s70
    v_mad_i32_i24 v26, v27, s71, v26
    s_add_u32 m0, s72, 0
    s_nop 0
    buffer_load_dwordx4 v26, s[32:35], 0 offen lds
    v_add_u32 v26, 128, v25
    v_mul_u32_u24 v27, 1009, v26
    v_lshrrev_b32 v27, 18, v27
    v_lshl_add_u32 v26, v26, 4, s70
    v_mad_i32_i24 v26, v27, s71, v26
    s_add_u32 m0, s72, 2048
    s_nop 0
    buffer_load_dwordx4 v26, s[32:35], 0 offen lds
    v_add_u32 v26, 256, v25
    v_mul_u32_u24 v27, 1009, v26
    v_lshrrev_b32 v27, 18, v27
    v_lshl_add_u32 v26, v26, 4, s70
    v_mad_i32_i24 v26, v27, s71, v26
    s_add_u32 m0, s72, 4096
    s_nop 0
    buffer_load_dwordx4 v26, s[32:35], 0 offen lds
    v_add_u32 v26, 384, v25
    v_mul_u32_u24 v27, 1009, v26
    v_lshrrev_b32 v27, 18, v27
    v_lshl_add_u32 v26, v26, 4, s70
    v_mad_i32_i24 v26, v27, s71, v26
    s_add_u32 m0, s72, 6144
    s_nop 0
    buffer_load_dwordx4 v26, s[32:35], 0 offen lds
    v_add_u32 v26, 512, v25
    v_mul_u32_u24 v27, 1009, v26
    v_lshrrev_b32 v27, 18, v27
    v_lshl_add_u32 v26, v26, 4, s70
    v_mad_i32_i24 v26, v27, s71, v26
    s_add_u32 m0, s72, 8192
    s_nop 0
    buffer_load_dwordx4 v26, s[32:35], 0 offen lds
    v_add_u32 v26, 640, v25
    v_mul_u32_u24 v27, 1009, v26
    v_lshrrev_b32 v27, 18, v27
    v_lshl_add_u32 v26, v26, 4, s70
    v_mad_i32_i24 v26, v27, s71, v26
    s_add_u32 m0, s72, 10240
    s_nop 0
    buffer_load_dwordx4 v26, s[32:35], 0 offen lds
    v_add_u32 v26, 768, v25
    v_mul_u32_u24 v27, 1009, v26
    v_lshrrev_b32 v27, 18, v27
    v_lshl_add_u32 v26, v26, 4, s70
    v_mad_i32_i24 v26, v27, s71, v26
    s_add_u32 m0, s72, 12288
    s_nop 0
    buffer_load_dwordx4 v26, s[32:35], 0 offen lds
    v_add_u32 v26, 896, v25
    v_mul_u32_u24 v27, 1009, v26
    v_lshrrev_b32 v27, 18, v27
    v_lshl_add_u32 v26, v26, 4, s70
    v_mad_i32_i24 v26, v27, s71, v26
    s_add_u32 m0, s72, 14336
    s_nop 0
    buffer_load_dwordx4 v26, s[32:35], 0 offen lds
    s_cmp_eq_u32 s55, 0
    s_cbranch_scc0 KA_NOLAST
    v_cmp_gt_u32 vcc, 16, v2
    s_and_saveexec_b64 s[74:75], vcc
    v_add_u32 v26, 1024, v25
    v_mul_u32_u24 v27, 1009, v26
    v_lshrrev_b32 v27, 18, v27
    v_lshl_add_u32 v26, v26, 4, s70
    v_mad_i32_i24 v26, v27, s71, v26
    s_add_u32 m0, s72, 16384
    s_nop 0
    buffer_load_dwordx4 v26, s[32:35], 0 offen lds
    s_mov_b64 exec, s[74:75]
KA_NOLAST:
    v_lshrrev_b32 v26, 3, v2
    v_and_b32 v26, 3, v26
    v_and_b32 v27, 7, v2
    v_add_u32 v28, v26, v27
    v_subrev_u32 v28, 3, v28
    v_lshlrev_b32 v28, 1, v28
    buffer_load_ushort v30, v28, s[32:35], 0 offen
    v_mul_u32_u24 v26, 4160, v26
    v_lshlrev_b32 v27, 1, v27
    v_add3_u32 v31, v26, v27, s59
    v_add_u32 v31, 48, v31
    s_mov_b32 s16, s12
    s_mov_b32 s17, s13
    s_mov_b32 s18, 2097152
    s_mov_b32 s19, 0x00020000
    s_add_u32 s20, s12, 2097152
    s_addc_u32 s21, s13, 0
    s_mov_b32 s22, 2097152
    s_mov_b32 s23, 0x00020000
    s_add_u32 s24, s12, 4194304
    s_addc_u32 s25, s13, 0
    s_mov_b32 s26, 16384
    s_mov_b32 s27, 0x00020000
    v_and_b32 v9, 7, v3
    v_sub_u32 v10, 7, v4
    v_xor_b32 v10, v10, v9
    v_lshlrev_b32 v10, 4, v10
    v_lshlrev_b32 v11, 8, v3
    v_add_u32 v10, v10, v11
    v_add_u32 v14, 54272, v10
    v_xor_b32 v9, v4, v9
    v_lshlrev_b32 v9, 4, v9
    v_add_u32 v9, v9, v11
    v_add_u32 v15, 62464, v9
    v_lshrrev_b32 v9, 3, v2
    s_lshl_b32 s63, s50, 4
    v_add_u32 v9, s63, v9
    v_lshrrev_b32 v10, 1, v9
    v_and_b32 v10, 7, v10
    v_and_b32 v11, 7, v2
    v_xor_b32 v10, v10, v11
    v_lshlrev_b32 v10, 4, v10
    v_lshlrev_b32 v12, 7, v9
    v_add_u32 v10, v10, v12
    v_add_u32 v10, 54272, v10
    v_xor_b32 v13, 64, v10
    s_lshl_b32 s63, s14, 6
    v_add_u32 v9, s63, v9
    v_lshlrev_b32 v9, 12, v9
    v_lshlrev_b32 v11, 4, v11
    v_add_u32 v9, v9, v11
    s_lshl_b32 s63, s3, 7
    v_add_u32 v12, s63, v9
    s_sub_u32 s63, 3968, s63
    v_add_u32 v9, s63, v9
    s_mov_b32 s15, 0x8000
    s_waitcnt vmcnt(27)
    v_lshlrev_b32 v160, 16, v110
    v_and_b32 v161, 0xffff0000, v110
    v_lshlrev_b32 v162, 16, v111
    v_and_b32 v163, 0xffff0000, v111
    v_lshlrev_b32 v164, 16, v112
    v_and_b32 v165, 0xffff0000, v112
    v_lshlrev_b32 v166, 16, v113
    v_and_b32 v167, 0xffff0000, v113
    v_lshlrev_b32 v168, 16, v114
    v_and_b32 v169, 0xffff0000, v114
    v_lshlrev_b32 v170, 16, v115
    v_and_b32 v171, 0xffff0000, v115
    v_lshlrev_b32 v172, 16, v116
    v_and_b32 v173, 0xffff0000, v116
    v_lshlrev_b32 v174, 16, v117
    v_and_b32 v175, 0xffff0000, v117
    v_lshlrev_b32 v176, 16, v118
    v_and_b32 v177, 0xffff0000, v118
    v_lshlrev_b32 v178, 16, v119
    v_and_b32 v179, 0xffff0000, v119
    v_lshlrev_b32 v180, 16, v120
    v_and_b32 v181, 0xffff0000, v120
    v_lshlrev_b32 v182, 16, v140
    v_lshlrev_b32 v183, 16, v142
    v_and_b32 v184, 0xffff0000, v140
    v_and_b32 v185, 0xffff0000, v142
    v_lshlrev_b32 v186, 16, v141
    v_lshlrev_b32 v187, 16, v143
    v_and_b32 v188, 0xffff0000, v141
    v_and_b32 v189, 0xffff0000, v143
    v_pk_mul_f32 v[64:65], v[166:167], v[182:183]
    v_pk_fma_f32 v[64:65], v[164:165], v[184:185], v[64:65]
    v_pk_fma_f32 v[64:65], v[162:163], v[186:187], v[64:65]
    v_pk_fma_f32 v[64:65], v[160:161], v[188:189], v[64:65]
    v_pk_mul_f32 v[66:67], v[168:169], v[182:183]
    v_pk_fma_f32 v[66:67], v[166:167], v[184:185], v[66:67]
    v_pk_fma_f32 v[66:67], v[164:165], v[186:187], v[66:67]
    v_pk_fma_f32 v[66:67], v[162:163], v[188:189], v[66:67]
    v_pk_mul_f32 v[68:69], v[170:171], v[182:183]
    v_pk_fma_f32 v[68:69], v[168:169], v[184:185], v[68:69]
    v_pk_fma_f32 v[68:69], v[166:167], v[186:187], v[68:69]
    v_pk_fma_f32 v[68:69], v[164:165], v[188:189], v[68:69]
    v_pk_mul_f32 v[70:71], v[172:173], v[182:183]
    v_pk_fma_f32 v[70:71], v[170:171], v[184:185], v[70:71]
    v_pk_fma_f32 v[70:71], v[168:169], v[186:187], v[70:71]
    v_pk_fma_f32 v[70:71], v[166:167], v[188:189], v[70:71]
    v_pk_mul_f32 v[72:73], v[174:175], v[182:183]
    v_pk_fma_f32 v[72:73], v[172:173], v[184:185], v[72:73]
    v_pk_fma_f32 v[72:73], v[170:171], v[186:187], v[72:73]
    v_pk_fma_f32 v[72:73], v[168:169], v[188:189], v[72:73]
    v_pk_mul_f32 v[74:75], v[176:177], v[182:183]
    v_pk_fma_f32 v[74:75], v[174:175], v[184:185], v[74:75]
    v_pk_fma_f32 v[74:75], v[172:173], v[186:187], v[74:75]
    v_pk_fma_f32 v[74:75], v[170:171], v[188:189], v[74:75]
    v_pk_mul_f32 v[76:77], v[178:179], v[182:183]
    v_pk_fma_f32 v[76:77], v[176:177], v[184:185], v[76:77]
    v_pk_fma_f32 v[76:77], v[174:175], v[186:187], v[76:77]
    v_pk_fma_f32 v[76:77], v[172:173], v[188:189], v[76:77]
    v_pk_mul_f32 v[78:79], v[180:181], v[182:183]
    v_pk_fma_f32 v[78:79], v[178:179], v[184:185], v[78:79]
    v_pk_fma_f32 v[78:79], v[176:177], v[186:187], v[78:79]
    v_pk_fma_f32 v[78:79], v[174:175], v[188:189], v[78:79]
    s_waitcnt vmcnt(19)
    v_lshlrev_b32 v80, 16, v121
    v_and_b32 v81, 0xffff0000, v121
    v_lshlrev_b32 v82, 16, v122
    v_and_b32 v83, 0xffff0000, v122
    v_lshlrev_b32 v84, 16, v123
    v_and_b32 v85, 0xffff0000, v123
    v_lshlrev_b32 v86, 16, v124
    v_and_b32 v87, 0xffff0000, v124
    v_lshlrev_b32 v88, 16, v125
    v_and_b32 v89, 0xffff0000, v125
    v_lshlrev_b32 v90, 16, v126
    v_and_b32 v91, 0xffff0000, v126
    v_lshlrev_b32 v92, 16, v127
    v_and_b32 v93, 0xffff0000, v127
    v_lshlrev_b32 v94, 16, v128
    v_and_b32 v95, 0xffff0000, v128
    v_pk_mul_f32 v[64:65], v[64:65], v[80:81]
    v_pk_mul_f32 v[66:67], v[66:67], v[82:83]
    v_pk_mul_f32 v[68:69], v[68:69], v[84:85]
    v_pk_mul_f32 v[70:71], v[70:71], v[86:87]
    v_pk_mul_f32 v[72:73], v[72:73], v[88:89]
    v_pk_mul_f32 v[74:75], v[74:75], v[90:91]
    v_pk_mul_f32 v[76:77], v[76:77], v[92:93]
    v_pk_mul_f32 v[78:79], v[78:79], v[94:95]
    v_cvt_pk_bf16_f32 v96, v78, v76
    v_cvt_pk_bf16_f32 v97, v74, v72
    v_cvt_pk_bf16_f32 v98, v70, v68
    v_cvt_pk_bf16_f32 v99, v66, v64
    v_cvt_pk_bf16_f32 v100, v79, v77
    v_cvt_pk_bf16_f32 v101, v75, v73
    v_cvt_pk_bf16_f32 v102, v71, v69
    v_cvt_pk_bf16_f32 v103, v67, v65
    ds_write_b128 v14, v[96:99]
    ds_write_b128 v14, v[100:103] offset:128
    s_cmp_eq_u32 s50, 0
    s_cbranch_scc0 KA_NOND
    v_mov_b32 v26, 0
    buffer_load_dword v29, v26, s[64:67], 0 offen
KA_NOND:
    s_waitcnt lgkmcnt(0)
    s_barrier
    ds_read_b128 v[96:99], v10
    ds_read_b128 v[100:103], v13 offset:1024
    s_waitcnt lgkmcnt(0)
    buffer_store_dwordx4 v[96:99], v9, s[16:19], 0 offen sc0 sc1
    buffer_store_dwordx4 v[100:103], v9, s[16:19], s15 offen sc0 sc1
    s_waitcnt vmcnt(13)
    v_perm_b32 v104, v130, v129, s60
    v_perm_b32 v105, v132, v131, s60
    v_perm_b32 v106, v134, v133, s60
    v_perm_b32 v107, v136, v135, s60
    v_perm_b32 v108, v130, v129, s61
    v_perm_b32 v109, v132, v131, s61
    v_perm_b32 v110, v134, v133, s61
    v_perm_b32 v111, v136, v135, s61
    ds_write_b128 v15, v[104:107]
    ds_write_b128 v15, v[108:111] offset:128
    s_waitcnt vmcnt(11)
    v_mov_b32 v76, 0
    v_mov_b32 v77, 0
    v_mov_b32 v78, 0
    v_mov_b32 v79, 0
    v_dot2c_f32_bf16 v76, s62, v144
    v_dot2c_f32_bf16 v77, v144, v144
    v_dot2c_f32_bf16 v78, s62, v148
    v_dot2c_f32_bf16 v79, v148, v148
    v_dot2c_f32_bf16 v76, s62, v145
    v_dot2c_f32_bf16 v77, v145, v145
    v_dot2c_f32_bf16 v78, s62, v149
    v_dot2c_f32_bf16 v79, v149, v149
    v_dot2c_f32_bf16 v76, s62, v146
    v_dot2c_f32_bf16 v77, v146, v146
    v_dot2c_f32_bf16 v78, s62, v150
    v_dot2c_f32_bf16 v79, v150, v150
    v_dot2c_f32_bf16 v76, s62, v147
    v_dot2c_f32_bf16 v77, v147, v147
    v_dot2c_f32_bf16 v78, s62, v151
    v_dot2c_f32_bf16 v79, v151, v151
    s_nop 2
    v_add_f32_dpp v76, v76, v76 row_shr:1 row_mask:0xf bank_mask:0xf
    v_add_f32_dpp v77, v77, v77 row_shr:1 row_mask:0xf bank_mask:0xf
    v_add_f32_dpp v78, v78, v78 row_shr:1 row_mask:0xf bank_mask:0xf
    v_add_f32_dpp v79, v79, v79 row_shr:1 row_mask:0xf bank_mask:0xf
    v_add_f32_dpp v76, v76, v76 row_shr:2 row_mask:0xf bank_mask:0xf
    v_add_f32_dpp v77, v77, v77 row_shr:2 row_mask:0xf bank_mask:0xf
    v_add_f32_dpp v78, v78, v78 row_shr:2 row_mask:0xf bank_mask:0xf
    v_add_f32_dpp v79, v79, v79 row_shr:2 row_mask:0xf bank_mask:0xf
    v_add_f32_dpp v76, v76, v76 row_shr:4 row_mask:0xf bank_mask:0xf
    v_add_f32_dpp v77, v77, v77 row_shr:4 row_mask:0xf bank_mask:0xf
    v_add_f32_dpp v78, v78, v78 row_shr:4 row_mask:0xf bank_mask:0xf
    v_add_f32_dpp v79, v79, v79 row_shr:4 row_mask:0xf bank_mask:0xf
    v_add_f32_dpp v76, v76, v76 row_shr:8 row_mask:0xf bank_mask:0xf
    v_add_f32_dpp v77, v77, v77 row_shr:8 row_mask:0xf bank_mask:0xf
    v_add_f32_dpp v78, v78, v78 row_shr:8 row_mask:0xf bank_mask:0xf
    v_add_f32_dpp v79, v79, v79 row_shr:8 row_mask:0xf bank_mask:0xf
    v_add_f32_dpp v76, v76, v76 row_bcast:15 row_mask:0xa bank_mask:0xf
    v_add_f32_dpp v77, v77, v77 row_bcast:15 row_mask:0xa bank_mask:0xf
    v_add_f32_dpp v78, v78, v78 row_bcast:15 row_mask:0xa bank_mask:0xf
    v_add_f32_dpp v79, v79, v79 row_bcast:15 row_mask:0xa bank_mask:0xf
    v_add_f32_dpp v76, v76, v76 row_bcast:31 row_mask:0xc bank_mask:0xf
    v_add_f32_dpp v77, v77, v77 row_bcast:31 row_mask:0xc bank_mask:0xf
    v_add_f32_dpp v78, v78, v78 row_bcast:31 row_mask:0xc bank_mask:0xf
    v_add_f32_dpp v79, v79, v79 row_bcast:31 row_mask:0xc bank_mask:0xf
    s_mov_b32 s63, 0x3b000000
    s_mov_b32 s73, 0x3727c5ac
    v_mul_f32 v76, s63, v76
    v_mul_f32 v77, s63, v77
    v_fma_f32 v77, -v76, v76, v77
    v_max_f32 v77, 0, v77
    v_add_f32 v77, s73, v77
    v_rsq_f32 v80, v77
    v_mul_f32 v78, s63, v78
    v_mul_f32 v79, s63, v79
    v_fma_f32 v79, -v78, v78, v79
    v_max_f32 v79, 0, v79
    v_add_f32 v79, s73, v79
    v_rsq_f32 v81, v79
    s_nop 0
    v_mul_f32 v82, v76, v80
    v_mul_f32 v83, v78, v81
    v_sub_f32 v82, 0, v82
    v_sub_f32 v83, 0, v83
    s_lshl_b32 s63, s51, 2
    v_mov_b32 v84, s63
    v_mov_b32 v85, 0x7fffffff
    v_cmp_eq_u32 vcc, 63, v2
    s_nop 1
    v_cndmask_b32 v84, v85, v84, vcc
    s_cmp_eq_u32 s50, 0
    s_cbranch_scc0 KA_NONCE
    s_mov_b32 s63, 0
    s_waitcnt vmcnt(2)
    v_cmp_eq_u32 vcc, 0, v29
    s_cbranch_vccz KA_NGOT
KA_NPOLL:
    v_mov_b32 v26, 0
    buffer_load_dword v29, v26, s[64:67], 0 offen sc0 sc1
    s_waitcnt vmcnt(0)
    v_cmp_eq_u32 vcc, 0, v29
    s_add_u32 s63, s63, 1
    s_cbranch_vccz KA_NGOT
    s_sleep 4
    s_cmp_lt_u32 s63, 0x40000
    s_cbranch_scc1 KA_NPOLL
KA_NGOT:
    v_mov_b32 v26, 71680
    ds_write_b32 v26, v29
KA_NONCE:
    s_lshl_b32 s63, s14, 7
    s_lshl_b32 s73, s3, 2
    s_add_u32 s73, s73, s63
    v_mov_b32 v1, s73
    v_mov_b32 v27, 0x7fffffff
    v_cmp_eq_u32 vcc, 0, v2
    s_nop 1
    v_cndmask_b32 v1, v27, v1, vcc
    s_waitcnt vmcnt(0)
    s_waitcnt lgkmcnt(0)
    s_barrier
    s_add_u32 s44, s12, 4399104
    s_addc_u32 s45, s13, 0
    s_mov_b32 s46, 2048
    s_mov_b32 s47, 0x00020000
    v_mov_b32 v26, 71680
    ds_read_b32 v29, v26
    ds_read_b128 v[104:107], v10 offset:8192
    ds_read_b128 v[108:111], v13 offset:9216
    s_waitcnt lgkmcnt(2)
    s_cmp_eq_u32 s50, 0
    s_cbranch_scc0 KA_NOFLAG
    buffer_store_dword v29, v1, s[44:47], 0 offen sc0 sc1
KA_NOFLAG:
    s_waitcnt lgkmcnt(0)
    buffer_store_dwordx4 v[104:107], v12, s[20:23], 0 offen sc0 sc1
    buffer_store_dwordx4 v[108:111], v12, s[20:23], s15 offen sc0 sc1
    s_mov_b32 s63, 8192
    buffer_store_dwordx2 v[80:81], v84, s[24:27], 0 offen sc0 sc1
    buffer_store_dwordx2 v[82:83], v84, s[24:27], s63 offen sc0 sc1
    s_load_dwordx2 s[4:5], s[0:1], 56
    s_load_dwordx2 s[6:7], s[0:1], 80
    s_waitcnt lgkmcnt(0)
    s_cmp_lt_u32 s2, 224
    s_cbranch_scc0 KA_J1O
    s_mov_b32 s36, s4
    s_mov_b32 s37, s5
    s_mov_b32 s38, 1835008
    s_mov_b32 s39, 0x00020000
    s_mov_b32 s48, 3584
    s_mul_i32 s49, s2, 293
    s_lshr_b32 s49, s49, 13
    s_mul_i32 s52, s49, 28
    s_sub_u32 s52, s2, s52
    s_mov_b32 s15, 32768
    s_mov_b32 s78, s49
    s_mov_b32 s79, s52
    s_branch KA_J1L
KA_J1O:
    s_sub_u32 s76, s2, 224
    s_mov_b32 s36, s6
    s_mov_b32 s37, s7
    s_mov_b32 s38, 917504
    s_mov_b32 s39, 0x00020000
    s_mov_b32 s48, 1024
    s_lshr_b32 s49, s76, 3
    s_and_b32 s52, s76, 7
    s_mov_b32 s15, 57344
KA_J1L:
    s_lshl_b32 s63, s49, 6
    s_mul_i32 s63, s63, s48
    s_lshl_b32 s73, s52, 7
    s_add_u32 s63, s63, s73
    s_lshl_b32 s73, s48, 3
    v_mul_lo_u32 v26, s73, v4
    v_lshlrev_b32 v27, 2, v3
    v_add3_u32 v26, v26, v27, s63
    s_mov_b32 s63, 0
    buffer_load_dword v200, v26, s[36:39], s63 offen
    s_add_u32 s63, s63, s48
    buffer_load_dword v201, v26, s[36:39], s63 offen
    s_add_u32 s63, s63, s48
    buffer_load_dword v202, v26, s[36:39], s63 offen
    s_add_u32 s63, s63, s48
    buffer_load_dword v203, v26, s[36:39], s63 offen
    s_add_u32 s63, s63, s48
    buffer_load_dword v204, v26, s[36:39], s63 offen
    s_add_u32 s63, s63, s48
    buffer_load_dword v205, v26, s[36:39], s63 offen
    s_add_u32 s63, s63, s48
    buffer_load_dword v206, v26, s[36:39], s63 offen
    s_add_u32 s63, s63, s48
    buffer_load_dword v207, v26, s[36:39], s63 offen
    v_lshrrev_b32 v26, 4, v3
    s_lshl_b32 s63, s52, 1
    v_add_u32 v26, s63, v26
    v_mul_lo_u32 v26, s15, v26
    s_lshl_b32 s63, s49, 3
    v_add_u32 v27, s63, v4
    v_lshrrev_b32 v28, 1, v27
    v_lshlrev_b32 v28, 10, v28
    v_and_b32 v27, 1, v27
    v_lshlrev_b32 v27, 9, v27
    v_add3_u32 v26, v26, v28, v27
    v_and_b32 v27, 15, v3
    v_lshlrev_b32 v27, 5, v27
    v_add_u32 v216, v26, v27
    s_add_u32 s76, s2, 32
    s_mov_b32 s36, s6
    s_mov_b32 s37, s7
    s_mov_b32 s38, 917504
    s_mov_b32 s39, 0x00020000
    s_mov_b32 s48, 1024
    s_lshr_b32 s49, s76, 3
    s_and_b32 s52, s76, 7
    s_mov_b32 s15, 57344
    s_cmp_lt_u32 s2, 80
    s_cselect_b32 s38, s38, 0
    s_lshl_b32 s63, s49, 6
    s_mul_i32 s63, s63, s48
    s_lshl_b32 s73, s52, 7
    s_add_u32 s63, s63, s73
    s_lshl_b32 s73, s48, 3
    v_mul_lo_u32 v26, s73, v4
    v_lshlrev_b32 v27, 2, v3
    v_add3_u32 v26, v26, v27, s63
    s_mov_b32 s63, 0
    buffer_load_dword v208, v26, s[36:39], s63 offen
    s_add_u32 s63, s63, s48
    buffer_load_dword v209, v26, s[36:39], s63 offen
    s_add_u32 s63, s63, s48
    buffer_load_dword v210, v26, s[36:39], s63 offen
    s_add_u32 s63, s63, s48
    buffer_load_dword v211, v26, s[36:39], s63 offen
    s_add_u32 s63, s63, s48
    buffer_load_dword v212, v26, s[36:39], s63 offen
    s_add_u32 s63, s63, s48
    buffer_load_dword v213, v26, s[36:39], s63 offen
    s_add_u32 s63, s63, s48
    buffer_load_dword v214, v26, s[36:39], s63 offen
    s_add_u32 s63, s63, s48
    buffer_load_dword v215, v26, s[36:39], s63 offen
    v_lshrrev_b32 v26, 4, v3
    s_lshl_b32 s63, s52, 1
    v_add_u32 v26, s63, v26
    v_mul_lo_u32 v26, s15, v26
    s_lshl_b32 s63, s49, 3
    v_add_u32 v27, s63, v4
    v_lshrrev_b32 v28, 1, v27
    v_lshlrev_b32 v28, 10, v28
    v_and_b32 v27, 1, v27
    v_lshlrev_b32 v27, 9, v27
    v_add3_u32 v26, v26, v28, v27
    v_and_b32 v27, 15, v3
    v_lshlrev_b32 v27, 5, v27
    v_add_u32 v217, v26, v27
    s_cmp_eq_u32 s55, 0
    s_cbranch_scc0 KA_NOFIX
    v_cmp_gt_u32 vcc, 32, v2
    s_and_saveexec_b64 s[74:75], vcc
    ds_write_b16 v31, v30
    s_mov_b64 exec, s[74:75]
KA_NOFIX:
    s_add_u32 s36, s12, 4259840
    s_addc_u32 s37, s13, 0
    s_mov_b32 s38, 131072
    s_mov_b32 s39, 0x00020000
    s_add_u32 s4, s12, 4390912
    s_addc_u32 s5, s13, 0
    s_mov_b32 s6, 8192
    s_mov_b32 s7, 0x00020000
    v_mov_b32 v180, -1
    v_mov_b32 v181, -1
    v_mov_b32 v182, -1
    v_mov_b32 v183, -1
    v_mov_b32 v184, 0
    v_mov_b32 v185, 0
    v_mov_b32 v186, 0
    v_mov_b32 v187, 0
    s_lshl_b32 s63, s2, 9
    v_lshlrev_b32 v188, 4, v0
    v_add_u32 v188, s63, v188
    v_cmp_gt_u32 vcc, 32, v0
    v_mov_b32 v189, 0x7fffffff
    s_nop 0
    v_cndmask_b32 v188, v189, v188, vcc
    buffer_store_dwordx4 v[180:183], v188, s[36:39], 0 offen
    buffer_store_dwordx4 v[184:187], v188, s[4:7], 0 offen
    s_add_u32 s16, s12, s57
    s_addc_u32 s17, s13, 0
    s_mov_b32 s18, 4096
    s_mov_b32 s19, 0x00020000
    s_add_u32 s24, s12, 2097152
    s_addc_u32 s25, s13, 0
    s_add_u32 s24, s24, s57
    s_addc_u32 s25, s25, 0
    s_mov_b32 s26, 4096
    s_mov_b32 s27, 0x00020000
    s_add_u32 s28, s12, 4194304
    s_addc_u32 s29, s13, 0
    s_mov_b32 s30, 16384
    s_mov_b32 s31, 0x00020000
    s_add_u32 s32, s12, 5242880
    s_addc_u32 s33, s13, 0
    s_add_u32 s32, s32, s58
    s_addc_u32 s33, s33, 0
    s_mov_b32 s34, 4096
    s_mov_b32 s35, 0x00020000
    s_lshl_b32 s63, s14, 7
    s_lshl_b32 s73, s3, 2
    s_add_u32 s63, s63, s73
    s_load_dword s76, s[42:43], s63
    s_xor_b32 s63, s55, 1
    s_lshl_b32 s63, s63, 3
    v_lshlrev_b32 v6, 4, v2
    v_add_u32 v6, s63, v6
    v_add_u32 v7, 4096, v6
    s_mul_i32 s66, s55, 5152
    s_add_u32 s66, s66, s59
    s_add_u32 s66, s66, 16640
    v_and_b32 v13, 15, v2
    v_lshrrev_b32 v14, 4, v2
    v_lshrrev_b32 v15, 1, v13
    v_lshlrev_b32 v15, 5, v15
    v_lshlrev_b32 v16, 3, v14
    v_and_b32 v17, 1, v13
    v_lshlrev_b32 v18, 2, v17
    v_add3_u32 v15, v15, v16, v18
    s_lshl_b32 s67, s55, 11
    v_lshlrev_b32 v19, 1, v15
    v_add_u32 v20, s67, v19
    v_lshlrev_b32 v21, 1, v20
    v_and_b32 v22, 3, v13
    v_mul_u32_u24 v22, 4160, v22
    v_lshrrev_b32 v23, 2, v13
    v_add_u32 v23, v23, v14
    v_lshlrev_b32 v23, 4, v23
    s_lshl_b32 s69, s55, 8
    s_add_u32 s69, s69, s59
    v_add3_u32 v22, v22, v23, s69
    v_mul_u32_u24 v23, 5152, v17
    v_lshrrev_b32 v24, 1, v13
    v_lshlrev_b32 v24, 6, v24
    v_sub_u32 v23, v23, v24
    v_lshlrev_b32 v24, 4, v14
    s_add_u32 s70, s69, 17088
    v_add3_u32 v23, v23, v24, s70
    s_add_u32 s71, s59, 24344
    v_sub_u32 v24, s71, v20
    s_waitcnt vmcnt(18)
    s_barrier
    s_cmp_eq_u32 s50, 0
    s_cbranch_scc0 KA_NOFLAGB
    buffer_store_dword v29, v1, s[44:47], 0 offen offset:1024 sc0 sc1
KA_NOFLAGB:
    v_and_b32 v25, 31, v2
    v_lshlrev_b32 v25, 2, v25
    s_lshl_b32 s63, s14, 7
    v_add_u32 v25, s63, v25
    s_mov_b32 s63, 0
KA_POLLA:
    buffer_load_dword v26, v25, s[44:47], 0 offen sc0 sc1
    s_waitcnt vmcnt(0)
    v_cmp_ne_u32 vcc, v26, v29
    s_add_u32 s63, s63, 1
    s_cbranch_vccz KA_GOTA
    s_cmp_lt_u32 s63, 0x40000
    s_cbranch_scc1 KA_POLLA
KA_GOTA:
    s_mov_b32 m0, s66
    s_nop 0
    buffer_load_dwordx4 v6, s[16:19], 0 offen offset:0 lds
    buffer_load_dwordx4 v6, s[16:19], 0 offen offset:1024 lds
    buffer_load_dwordx4 v6, s[16:19], 0 offen offset:2048 lds
    buffer_load_dwordx4 v6, s[16:19], 0 offen offset:3072 lds
    s_add_u32 m0, s66, 4096
    s_nop 0
    buffer_load_dwordx4 v7, s[16:19], 0 offen lds
    s_add_u32 s36, s12, 8388608
    s_addc_u32 s37, s13, 0
    s_mov_b32 s38, 1835008
    s_mov_b32 s39, 0x00020000
    s_add_u32 s4, s12, 10485760
    s_addc_u32 s5, s13, 0
    s_mov_b32 s6, 917504
    s_mov_b32 s7, 0x00020000
    v_perm_b32 v160, v201, v200, s60
    v_perm_b32 v161, v203, v202, s60
    v_perm_b32 v162, v205, v204, s60
    v_perm_b32 v163, v207, v206, s60
    v_perm_b32 v164, v201, v200, s61
    v_perm_b32 v165, v203, v202, s61
    v_perm_b32 v166, v205, v204, s61
    v_perm_b32 v167, v207, v206, s61
    v_perm_b32 v168, v209, v208, s60
    v_perm_b32 v169, v211, v210, s60
    v_perm_b32 v170, v213, v212, s60
    v_perm_b32 v171, v215, v214, s60
    v_perm_b32 v172, v209, v208, s61
    v_perm_b32 v173, v211, v210, s61
    v_perm_b32 v174, v213, v212, s61
    v_perm_b32 v175, v215, v214, s61
    s_cmp_lt_u32 s2, 224
    s_cbranch_scc0 KA_J1SO
    buffer_store_dwordx4 v[160:163], v216, s[36:39], 0 offen
    buffer_store_dwordx4 v[164:167], v216, s[36:39], 0 offen offset:16
    v_mov_b32 v176, 0
    v_mov_b32 v177, 0
    v_dot2c_f32_bf16 v176, s62, v160
    v_dot2c_f32_bf16 v177, s62, v164
    v_dot2c_f32_bf16 v176, s62, v161
    v_dot2c_f32_bf16 v177, s62, v165
    v_dot2c_f32_bf16 v176, s62, v162
    v_dot2c_f32_bf16 v177, s62, v166
    v_dot2c_f32_bf16 v176, s62, v163
    v_dot2c_f32_bf16 v177, s62, v167
    s_nop 2
    v_permlane32_swap_b32 v176, v177
    s_nop 1
    v_add_f32 v176, v176, v177
    v_lshlrev_b32 v178, 2, v0
    v_add_u32 v178, 70656, v178
    ds_write_b32 v178, v176
    s_branch KA_J1SJ
KA_J1SO:
    buffer_store_dwordx4 v[160:163], v216, s[4:7], 0 offen
    buffer_store_dwordx4 v[164:167], v216, s[4:7], 0 offen offset:16
KA_J1SJ:
    s_cmp_lt_u32 s2, 80
    s_cbranch_scc0 KA_NOJ2
    buffer_store_dwordx4 v[168:171], v217, s[4:7], 0 offen
    buffer_store_dwordx4 v[172:175], v217, s[4:7], 0 offen offset:16
KA_NOJ2:
    v_lshlrev_b32 v26, 4, v2
    buffer_load_dwordx4 v[224:227], v26, s[44:47], 0 offen offset:1024 sc0 sc1
    s_waitcnt vmcnt(3) lgkmcnt(0)
    s_barrier
    s_cmp_lt_u32 s2, 224
    s_cselect_b32 s63, 1, 0
    s_cmp_eq_u32 s50, 0
    s_cselect_b32 s63, s63, 0
    s_cmp_eq_u32 s63, 1
    s_cbranch_scc0 KA_NOCS
    v_lshlrev_b32 v26, 2, v2
    v_add_u32 v26, 70656, v26
    ds_read_b32 v32, v26
    ds_read_b32 v33, v26 offset:256
    ds_read_b32 v34, v26 offset:512
    ds_read_b32 v35, v26 offset:768
    v_and_b32 v27, 31, v2
    v_lshlrev_b32 v27, 1, v27
    v_lshrrev_b32 v28, 5, v2
    v_add_u32 v27, v27, v28
    s_lshl_b32 s63, s79, 6
    s_mul_i32 s73, s78, 1792
    s_add_u32 s63, s63, s73
    v_add_u32 v27, s63, v27
    v_lshlrev_b32 v27, 2, v27
    s_add_u32 s4, s12, 4456448
    s_addc_u32 s5, s13, 0
    s_mov_b32 s6, 57344
    s_mov_b32 s7, 0x00020000
    s_waitcnt lgkmcnt(0)
    v_add_f32 v32, v32, v33
    v_add_f32 v34, v34, v35
    v_add_f32 v32, v32, v34
    buffer_store_dword v32, v27, s[4:7], 0 offen
KA_NOCS:
    ds_read_b128 v[96:99], v22 offset:0
    ds_read_b128 v[160:163], v23 offset:3584
    ds_read_b128 v[164:167], v23 offset:3072
    ds_read_b128 v[168:171], v23 offset:2560
    ds_read_b128 v[172:175], v23 offset:2048
    ds_read_b128 v[176:179], v23 offset:1536
    ds_read_b128 v[180:183], v23 offset:1024
    ds_read_b128 v[184:187], v23 offset:512
    ds_read_b128 v[188:191], v23 offset:0
    ds_read_b128 v[100:103], v22 offset:512
    ds_read_b128 v[104:107], v22 offset:1024
    ds_read_b128 v[108:111], v22 offset:1536
    ds_read_b128 v[112:115], v22 offset:2048
    ds_read_b128 v[116:119], v22 offset:2560
    ds_read_b128 v[120:123], v22 offset:3072
    ds_read_b128 v[124:127], v22 offset:3584
    s_load_dwordx2 s[8:9], s[0:1], 64
    s_lshl_b32 s73, s2, 2
    s_add_u32 s73, s73, s50
    s_lshl_b32 s73, s73, 13
    v_lshlrev_b32 v28, 7, v2
    s_mov_b32 s68, 8192
    s_waitcnt lgkmcnt(0)
    s_mov_b32 s36, s8
    s_mov_b32 s37, s9
    s_mov_b32 s38, 8388608
    s_mov_b32 s39, 0x00020000
    v_mfma_f32_16x16x32_bf16 v[64:67], v[96:99], v[160:163], 0
    ds_read_b128 v[128:131], v22 offset:64
    v_mfma_f32_16x16x32_bf16 v[68:71], v[96:99], v[164:167], 0
    ds_read_b128 v[192:195], v23 offset:3648
    v_mfma_f32_16x16x32_bf16 v[72:75], v[96:99], v[168:171], 0
    ds_read_b128 v[196:199], v23 offset:3136
    v_mfma_f32_16x16x32_bf16 v[76:79], v[96:99], v[172:175], 0
    ds_read_b128 v[200:203], v23 offset:2624
    v_mfma_f32_16x16x32_bf16 v[80:83], v[96:99], v[176:179], 0
    ds_read_b128 v[204:207], v23 offset:2112
    v_mfma_f32_16x16x32_bf16 v[84:87], v[96:99], v[180:183], 0
    ds_read_b128 v[208:211], v23 offset:1600
    v_mfma_f32_16x16x32_bf16 v[88:91], v[96:99], v[184:187], 0
    ds_read_b128 v[212:215], v23 offset:1088
    v_mfma_f32_16x16x32_bf16 v[92:95], v[96:99], v[188:191], 0
    ds_read_b128 v[216:219], v23 offset:576
    v_mfma_f32_16x16x32_bf16 v[68:71], v[100:103], v[160:163], v[68:71]
    ds_read_b128 v[220:223], v23 offset:64
    v_mfma_f32_16x16x32_bf16 v[72:75], v[100:103], v[164:167], v[72:75]
    ds_read_b128 v[132:135], v22 offset:576
    v_mfma_f32_16x16x32_bf16 v[76:79], v[100:103], v[168:171], v[76:79]
    ds_read_b128 v[136:139], v22 offset:1088
    v_mfma_f32_16x16x32_bf16 v[80:83], v[100:103], v[172:175], v[80:83]
    ds_read_b128 v[140:143], v22 offset:1600
    v_mfma_f32_16x16x32_bf16 v[84:87], v[100:103], v[176:179], v[84:87]
    ds_read_b128 v[144:147], v22 offset:2112
    v_mfma_f32_16x16x32_bf16 v[88:91], v[100:103], v[180:183], v[88:91]
    ds_read_b128 v[148:151], v22 offset:2624
    v_mfma_f32_16x16x32_bf16 v[92:95], v[100:103], v[184:187], v[92:95]
    ds_read_b128 v[152:155], v22 offset:3136
    v_mfma_f32_16x16x32_bf16 v[72:75], v[104:107], v[160:163], v[72:75]
    ds_read_b128 v[156:159], v22 offset:3648
    v_mfma_f32_16x16x32_bf16 v[76:79], v[104:107], v[164:167], v[76:79]
    v_mfma_f32_16x16x32_bf16 v[80:83], v[104:107], v[168:171], v[80:83]
    v_mfma_f32_16x16x32_bf16 v[84:87], v[104:107], v[172:175], v[84:87]
    v_mfma_f32_16x16x32_bf16 v[88:91], v[104:107], v[176:179], v[88:91]
    v_mfma_f32_16x16x32_bf16 v[92:95], v[104:107], v[180:183], v[92:95]
    v_mfma_f32_16x16x32_bf16 v[76:79], v[108:111], v[160:163], v[76:79]
    v_mfma_f32_16x16x32_bf16 v[80:83], v[108:111], v[164:167], v[80:83]
    v_mfma_f32_16x16x32_bf16 v[84:87], v[108:111], v[168:171], v[84:87]
    v_mfma_f32_16x16x32_bf16 v[88:91], v[108:111], v[172:175], v[88:91]
    v_mfma_f32_16x16x32_bf16 v[92:95], v[108:111], v[176:179], v[92:95]
    v_mfma_f32_16x16x32_bf16 v[80:83], v[112:115], v[160:163], v[80:83]
    v_mfma_f32_16x16x32_bf16 v[84:87], v[112:115], v[164:167], v[84:87]
    v_mfma_f32_16x16x32_bf16 v[88:91], v[112:115], v[168:171], v[88:91]
    v_mfma_f32_16x16x32_bf16 v[92:95], v[112:115], v[172:175], v[92:95]
    v_mfma_f32_16x16x32_bf16 v[84:87], v[116:119], v[160:163], v[84:87]
    v_mfma_f32_16x16x32_bf16 v[88:91], v[116:119], v[164:167], v[88:91]
    v_mfma_f32_16x16x32_bf16 v[92:95], v[116:119], v[168:171], v[92:95]
    v_mfma_f32_16x16x32_bf16 v[88:91], v[120:123], v[160:163], v[88:91]
    v_mfma_f32_16x16x32_bf16 v[92:95], v[120:123], v[164:167], v[92:95]
    v_mfma_f32_16x16x32_bf16 v[92:95], v[124:127], v[160:163], v[92:95]
    s_waitcnt lgkmcnt(0)
    s_waitcnt vmcnt(0)
    s_mov_b32 s63, 0
KA_ALLC:
    v_cmp_ne_u32 vcc, v224, v29
    v_cmp_ne_u32 s[74:75], v225, v29
    s_or_b64 vcc, vcc, s[74:75]
    v_cmp_ne_u32 s[74:75], v226, v29
    s_or_b64 vcc, vcc, s[74:75]
    v_cmp_ne_u32 s[74:75], v227, v29
    s_or_b64 vcc, vcc, s[74:75]
    s_cmp_eq_u64 vcc, 0
    s_cbranch_scc1 KA_ALLOK
    v_lshlrev_b32 v26, 4, v2
    buffer_load_dwordx4 v[224:227], v26, s[44:47], 0 offen offset:1024 sc0 sc1
    s_waitcnt vmcnt(0)
    s_add_u32 s63, s63, 1
    s_cmp_lt_u32 s63, 0x40000
    s_cbranch_scc1 KA_ALLC
KA_ALLOK:
    v_mfma_f32_16x16x32_bf16 v[64:67], v[128:131], v[192:195], v[64:67]
    ds_read_b128 v[96:99], v22 offset:128
    v_mfma_f32_16x16x32_bf16 v[68:71], v[128:131], v[196:199], v[68:71]
    ds_read_b128 v[160:163], v23 offset:3712
    v_mfma_f32_16x16x32_bf16 v[72:75], v[128:131], v[200:203], v[72:75]
    ds_read_b128 v[164:167], v23 offset:3200
    v_mfma_f32_16x16x32_bf16 v[76:79], v[128:131], v[204:207], v[76:79]
    ds_read_b128 v[168:171], v23 offset:2688
    v_mfma_f32_16x16x32_bf16 v[80:83], v[128:131], v[208:211], v[80:83]
    ds_read_b128 v[172:175], v23 offset:2176
    v_mfma_f32_16x16x32_bf16 v[84:87], v[128:131], v[212:215], v[84:87]
    ds_read_b128 v[176:179], v23 offset:1664
    v_mfma_f32_16x16x32_bf16 v[88:91], v[128:131], v[216:219], v[88:91]
    ds_read_b128 v[180:183], v23 offset:1152
    v_mfma_f32_16x16x32_bf16 v[92:95], v[128:131], v[220:223], v[92:95]
    ds_read_b128 v[184:187], v23 offset:640
    v_mfma_f32_16x16x32_bf16 v[68:71], v[132:135], v[192:195], v[68:71]
    ds_read_b128 v[188:191], v23 offset:128
    v_mfma_f32_16x16x32_bf16 v[72:75], v[132:135], v[196:199], v[72:75]
    ds_read_b128 v[100:103], v22 offset:640
    v_mfma_f32_16x16x32_bf16 v[76:79], v[132:135], v[200:203], v[76:79]
    ds_read_b128 v[104:107], v22 offset:1152
    v_mfma_f32_16x16x32_bf16 v[80:83], v[132:135], v[204:207], v[80:83]
    ds_read_b128 v[108:111], v22 offset:1664
    v_mfma_f32_16x16x32_bf16 v[84:87], v[132:135], v[208:211], v[84:87]
    ds_read_b128 v[112:115], v22 offset:2176
    v_mfma_f32_16x16x32_bf16 v[88:91], v[132:135], v[212:215], v[88:91]
    ds_read_b128 v[116:119], v22 offset:2688
    v_mfma_f32_16x16x32_bf16 v[92:95], v[132:135], v[216:219], v[92:95]
    ds_read_b128 v[120:123], v22 offset:3200
    v_mfma_f32_16x16x32_bf16 v[72:75], v[136:139], v[192:195], v[72:75]
    ds_read_b128 v[124:127], v22 offset:3712
    v_mfma_f32_16x16x32_bf16 v[76:79], v[136:139], v[196:199], v[76:79]
    buffer_load_dwordx2 v[32:33], v20, s[24:27], 0 offen offset:0
    v_mfma_f32_16x16x32_bf16 v[80:83], v[136:139], v[200:203], v[80:83]
    v_mfma_f32_16x16x32_bf16 v[84:87], v[136:139], v[204:207], v[84:87]
    v_mfma_f32_16x16x32_bf16 v[88:91], v[136:139], v[208:211], v[88:91]
    v_mfma_f32_16x16x32_bf16 v[92:95], v[136:139], v[212:215], v[92:95]
    buffer_load_dwordx2 v[34:35], v20, s[24:27], 0 offen offset:512
    v_mfma_f32_16x16x32_bf16 v[76:79], v[140:143], v[192:195], v[76:79]
    v_mfma_f32_16x16x32_bf16 v[80:83], v[140:143], v[196:199], v[80:83]
    v_mfma_f32_16x16x32_bf16 v[84:87], v[140:143], v[200:203], v[84:87]
    v_mfma_f32_16x16x32_bf16 v[88:91], v[140:143], v[204:207], v[88:91]
    buffer_load_dwordx2 v[36:37], v20, s[24:27], 0 offen offset:1024
    v_mfma_f32_16x16x32_bf16 v[92:95], v[140:143], v[208:211], v[92:95]
    v_mfma_f32_16x16x32_bf16 v[80:83], v[144:147], v[192:195], v[80:83]
    v_mfma_f32_16x16x32_bf16 v[84:87], v[144:147], v[196:199], v[84:87]
    v_mfma_f32_16x16x32_bf16 v[88:91], v[144:147], v[200:203], v[88:91]
    buffer_load_dwordx2 v[38:39], v20, s[24:27], 0 offen offset:1536
    v_mfma_f32_16x16x32_bf16 v[92:95], v[144:147], v[204:207], v[92:95]
    v_mfma_f32_16x16x32_bf16 v[84:87], v[148:151], v[192:195], v[84:87]
    v_mfma_f32_16x16x32_bf16 v[88:91], v[148:151], v[196:199], v[88:91]
    v_mfma_f32_16x16x32_bf16 v[92:95], v[148:151], v[200:203], v[92:95]
    buffer_load_dwordx4 v[40:43], v21, s[28:31], 0 offen offset:0
    v_mfma_f32_16x16x32_bf16 v[88:91], v[152:155], v[192:195], v[88:91]
    v_mfma_f32_16x16x32_bf16 v[92:95], v[152:155], v[196:199], v[92:95]
    v_mfma_f32_16x16x32_bf16 v[92:95], v[156:159], v[192:195], v[92:95]
    s_waitcnt lgkmcnt(0)
    v_mfma_f32_16x16x32_bf16 v[64:67], v[96:99], v[160:163], v[64:67]
    ds_read_b128 v[128:131], v22 offset:192
    v_mfma_f32_16x16x32_bf16 v[68:71], v[96:99], v[164:167], v[68:71]
    ds_read_b128 v[192:195], v23 offset:3776
    v_mfma_f32_16x16x32_bf16 v[72:75], v[96:99], v[168:171], v[72:75]
    ds_read_b128 v[196:199], v23 offset:3264
    v_mfma_f32_16x16x32_bf16 v[76:79], v[96:99], v[172:175], v[76:79]
    ds_read_b128 v[200:203], v23 offset:2752
    v_mfma_f32_16x16x32_bf16 v[80:83], v[96:99], v[176:179], v[80:83]
    ds_read_b128 v[204:207], v23 offset:2240
    v_mfma_f32_16x16x32_bf16 v[84:87], v[96:99], v[180:183], v[84:87]
    ds_read_b128 v[208:211], v23 offset:1728
    v_mfma_f32_16x16x32_bf16 v[88:91], v[96:99], v[184:187], v[88:91]
    ds_read_b128 v[212:215], v23 offset:1216
    v_mfma_f32_16x16x32_bf16 v[92:95], v[96:99], v[188:191], v[92:95]
    ds_read_b128 v[216:219], v23 offset:704
    v_mfma_f32_16x16x32_bf16 v[68:71], v[100:103], v[160:163], v[68:71]
    ds_read_b128 v[220:223], v23 offset:192
    v_mfma_f32_16x16x32_bf16 v[72:75], v[100:103], v[164:167], v[72:75]
    ds_read_b128 v[132:135], v22 offset:704
    v_mfma_f32_16x16x32_bf16 v[76:79], v[100:103], v[168:171], v[76:79]
    ds_read_b128 v[136:139], v22 offset:1216
    v_mfma_f32_16x16x32_bf16 v[80:83], v[100:103], v[172:175], v[80:83]
    ds_read_b128 v[140:143], v22 offset:1728
    v_mfma_f32_16x16x32_bf16 v[84:87], v[100:103], v[176:179], v[84:87]
    ds_read_b128 v[144:147], v22 offset:2240
    v_mfma_f32_16x16x32_bf16 v[88:91], v[100:103], v[180:183], v[88:91]
    ds_read_b128 v[148:151], v22 offset:2752
    v_mfma_f32_16x16x32_bf16 v[92:95], v[100:103], v[184:187], v[92:95]
    ds_read_b128 v[152:155], v22 offset:3264
    v_mfma_f32_16x16x32_bf16 v[72:75], v[104:107], v[160:163], v[72:75]
    ds_read_b128 v[156:159], v22 offset:3776
    v_mfma_f32_16x16x32_bf16 v[76:79], v[104:107], v[164:167], v[76:79]
    buffer_load_dwordx4 v[44:47], v21, s[28:31], 0 offen offset:1024
    v_mfma_f32_16x16x32_bf16 v[80:83], v[104:107], v[168:171], v[80:83]
    v_mfma_f32_16x16x32_bf16 v[84:87], v[104:107], v[172:175], v[84:87]
    v_mfma_f32_16x16x32_bf16 v[88:91], v[104:107], v[176:179], v[88:91]
    v_mfma_f32_16x16x32_bf16 v[92:95], v[104:107], v[180:183], v[92:95]
    buffer_load_dwordx4 v[48:51], v21, s[28:31], 0 offen offset:2048
    v_mfma_f32_16x16x32_bf16 v[76:79], v[108:111], v[160:163], v[76:79]
    v_mfma_f32_16x16x32_bf16 v[80:83], v[108:111], v[164:167], v[80:83]
    v_mfma_f32_16x16x32_bf16 v[84:87], v[108:111], v[168:171], v[84:87]
    v_mfma_f32_16x16x32_bf16 v[88:91], v[108:111], v[172:175], v[88:91]
    buffer_load_dwordx4 v[52:55], v21, s[28:31], 0 offen offset:3072
    v_mfma_f32_16x16x32_bf16 v[92:95], v[108:111], v[176:179], v[92:95]
    v_mfma_f32_16x16x32_bf16 v[80:83], v[112:115], v[160:163], v[80:83]
    v_mfma_f32_16x16x32_bf16 v[84:87], v[112:115], v[164:167], v[84:87]
    v_mfma_f32_16x16x32_bf16 v[88:91], v[112:115], v[168:171], v[88:91]
    buffer_load_dwordx4 v[224:227], v21, s[28:31], s68 offen offset:0
    v_mfma_f32_16x16x32_bf16 v[92:95], v[112:115], v[172:175], v[92:95]
    v_mfma_f32_16x16x32_bf16 v[84:87], v[116:119], v[160:163], v[84:87]
    v_mfma_f32_16x16x32_bf16 v[88:91], v[116:119], v[164:167], v[88:91]
    v_mfma_f32_16x16x32_bf16 v[92:95], v[116:119], v[168:171], v[92:95]
    buffer_load_dwordx4 v[228:231], v21, s[28:31], s68 offen offset:1024
    v_mfma_f32_16x16x32_bf16 v[88:91], v[120:123], v[160:163], v[88:91]
    v_mfma_f32_16x16x32_bf16 v[92:95], v[120:123], v[164:167], v[92:95]
    v_mfma_f32_16x16x32_bf16 v[92:95], v[124:127], v[160:163], v[92:95]
    s_waitcnt lgkmcnt(0)
    v_mfma_f32_16x16x32_bf16 v[64:67], v[128:131], v[192:195], v[64:67]
    buffer_load_dwordx4 v[232:235], v21, s[28:31], s68 offen offset:2048
    v_mfma_f32_16x16x32_bf16 v[68:71], v[128:131], v[196:199], v[68:71]
    v_mfma_f32_16x16x32_bf16 v[72:75], v[128:131], v[200:203], v[72:75]
    v_mfma_f32_16x16x32_bf16 v[76:79], v[128:131], v[204:207], v[76:79]
    v_mfma_f32_16x16x32_bf16 v[80:83], v[128:131], v[208:211], v[80:83]
    buffer_load_dwordx4 v[236:239], v21, s[28:31], s68 offen offset:3072
    v_mfma_f32_16x16x32_bf16 v[84:87], v[128:131], v[212:215], v[84:87]
    v_mfma_f32_16x16x32_bf16 v[88:91], v[128:131], v[216:219], v[88:91]
    v_mfma_f32_16x16x32_bf16 v[92:95], v[128:131], v[220:223], v[92:95]
    v_mfma_f32_16x16x32_bf16 v[68:71], v[132:135], v[192:195], v[68:71]
    buffer_load_dword v30, v28, s[36:39], s73 offen
    v_mfma_f32_16x16x32_bf16 v[72:75], v[132:135], v[196:199], v[72:75]
    v_mfma_f32_16x16x32_bf16 v[76:79], v[132:135], v[200:203], v[76:79]
    v_mfma_f32_16x16x32_bf16 v[80:83], v[132:135], v[204:207], v[80:83]
    v_mfma_f32_16x16x32_bf16 v[84:87], v[132:135], v[208:211], v[84:87]
    v_mfma_f32_16x16x32_bf16 v[88:91], v[132:135], v[212:215], v[88:91]
    v_mfma_f32_16x16x32_bf16 v[92:95], v[132:135], v[216:219], v[92:95]
    v_mfma_f32_16x16x32_bf16 v[72:75], v[136:139], v[192:195], v[72:75]
    v_mfma_f32_16x16x32_bf16 v[76:79], v[136:139], v[196:199], v[76:79]
    v_mfma_f32_16x16x32_bf16 v[80:83], v[136:139], v[200:203], v[80:83]
    v_mfma_f32_16x16x32_bf16 v[84:87], v[136:139], v[204:207], v[84:87]
    v_mfma_f32_16x16x32_bf16 v[88:91], v[136:139], v[208:211], v[88:91]
    v_mfma_f32_16x16x32_bf16 v[92:95], v[136:139], v[212:215], v[92:95]
    v_mfma_f32_16x16x32_bf16 v[76:79], v[140:143], v[192:195], v[76:79]
    v_mfma_f32_16x16x32_bf16 v[80:83], v[140:143], v[196:199], v[80:83]
    v_mfma_f32_16x16x32_bf16 v[84:87], v[140:143], v[200:203], v[84:87]
    v_mfma_f32_16x16x32_bf16 v[88:91], v[140:143], v[204:207], v[88:91]
    v_mfma_f32_16x16x32_bf16 v[92:95], v[140:143], v[208:211], v[92:95]
    v_mfma_f32_16x16x32_bf16 v[80:83], v[144:147], v[192:195], v[80:83]
    v_mfma_f32_16x16x32_bf16 v[84:87], v[144:147], v[196:199], v[84:87]
    v_mfma_f32_16x16x32_bf16 v[88:91], v[144:147], v[200:203], v[88:91]
    v_mfma_f32_16x16x32_bf16 v[92:95], v[144:147], v[204:207], v[92:95]
    v_mfma_f32_16x16x32_bf16 v[84:87], v[148:151], v[192:195], v[84:87]
    v_mfma_f32_16x16x32_bf16 v[88:91], v[148:151], v[196:199], v[88:91]
    v_mfma_f32_16x16x32_bf16 v[92:95], v[148:151], v[200:203], v[92:95]
    v_mfma_f32_16x16x32_bf16 v[88:91], v[152:155], v[192:195], v[88:91]
    v_mfma_f32_16x16x32_bf16 v[92:95], v[152:155], v[196:199], v[92:95]
    v_mfma_f32_16x16x32_bf16 v[92:95], v[156:159], v[192:195], v[92:95]
    s_lshl_b32 s72, s50, 12
    s_add_u32 s72, s72, 54272
    v_lshlrev_b32 v25, 4, v2
    v_add_u32 v26, s72, v25
    s_xor_b32 s73, s50, 1
    s_lshl_b32 s73, s73, 12
    s_add_u32 s73, s73, 54272
    v_add_u32 v27, s73, v25
    s_cmp_eq_u32 s55, 0
    s_nop 4
    s_cbranch_scc0 KA_XB
    ds_write_b128 v26, v[80:83] offset:0
    ds_write_b128 v26, v[84:87] offset:1024
    ds_write_b128 v26, v[88:91] offset:2048
    ds_write_b128 v26, v[92:95] offset:3072
    s_branch KA_XJ
KA_XB:
    ds_write_b128 v26, v[64:67] offset:0
    ds_write_b128 v26, v[68:71] offset:1024
    ds_write_b128 v26, v[72:75] offset:2048
    ds_write_b128 v26, v[76:79] offset:3072
KA_XJ:
    s_waitcnt lgkmcnt(0)
    s_barrier
    ds_read_b128 v[96:99], v27 offset:0
    ds_read_b128 v[100:103], v27 offset:1024
    ds_read_b128 v[104:107], v27 offset:2048
    ds_read_b128 v[108:111], v27 offset:3072
    ds_read_b64 v[112:113], v24 offset:1536
    ds_read_b64 v[114:115], v24 offset:1024
    ds_read_b64 v[116:117], v24 offset:512
    ds_read_b64 v[118:119], v24 offset:0
    s_lshl_b32 s74, s76, 16
    s_and_b32 s75, s76, 0xffff0000
    s_cmp_eq_u32 s54, 0
    s_cselect_b32 s74, s74, s75
    s_cmp_eq_u32 s55, 0
    s_waitcnt lgkmcnt(0)
    s_cbranch_scc0 KA_YB
    v_add_f32 v128, v64, v96
    v_add_f32 v129, v65, v97
    v_add_f32 v130, v66, v98
    v_add_f32 v131, v67, v99
    v_add_f32 v132, v68, v100
    v_add_f32 v133, v69, v101
    v_add_f32 v134, v70, v102
    v_add_f32 v135, v71, v103
    v_add_f32 v136, v72, v104
    v_add_f32 v137, v73, v105
    v_add_f32 v138, v74, v106
    v_add_f32 v139, v75, v107
    v_add_f32 v140, v76, v108
    v_add_f32 v141, v77, v109
    v_add_f32 v142, v78, v110
    v_add_f32 v143, v79, v111
    s_branch KA_YJ
KA_YB:
    v_add_f32 v128, v80, v96
    v_add_f32 v129, v81, v97
    v_add_f32 v130, v82, v98
    v_add_f32 v131, v83, v99
    v_add_f32 v132, v84, v100
    v_add_f32 v133, v85, v101
    v_add_f32 v134, v86, v102
    v_add_f32 v135, v87, v103
    v_add_f32 v136, v88, v104
    v_add_f32 v137, v89, v105
    v_add_f32 v138, v90, v106
    v_add_f32 v139, v91, v107
    v_add_f32 v140, v92, v108
    v_add_f32 v141, v93, v109
    v_add_f32 v142, v94, v110
    v_add_f32 v143, v95, v111
KA_YJ:
    s_waitcnt vmcnt(1)
    v_lshlrev_b32 v144, 16, v32
    v_and_b32 v145, 0xffff0000, v32
    v_lshlrev_b32 v146, 16, v33
    v_and_b32 v147, 0xffff0000, v33
    v_and_b32 v148, 0xffff0000, v113
    v_lshlrev_b32 v149, 16, v113
    v_and_b32 v150, 0xffff0000, v112
    v_lshlrev_b32 v151, 16, v112
    v_fma_f32 v128, v148, s74, v128
    v_fma_f32 v129, v149, s74, v129
    v_fma_f32 v130, v150, s74, v130
    v_fma_f32 v131, v151, s74, v131
    v_fma_f32 v148, v144, v40, v224
    v_fma_f32 v149, v145, v41, v225
    v_fma_f32 v150, v146, v42, v226
    v_fma_f32 v151, v147, v43, v227
    v_fma_f32 v128, v148, v128, v144
    v_fma_f32 v129, v149, v129, v145
    v_fma_f32 v130, v150, v130, v146
    v_fma_f32 v131, v151, v131, v147
    v_cvt_pk_bf16_f32 v152, v128, v129
    v_cvt_pk_bf16_f32 v153, v130, v131
    buffer_store_dwordx2 v[152:153], v20, s[32:35], 0 offen offset:0
    v_lshlrev_b32 v144, 16, v34
    v_and_b32 v145, 0xffff0000, v34
    v_lshlrev_b32 v146, 16, v35
    v_and_b32 v147, 0xffff0000, v35
    v_and_b32 v148, 0xffff0000, v115
    v_lshlrev_b32 v149, 16, v115
    v_and_b32 v150, 0xffff0000, v114
    v_lshlrev_b32 v151, 16, v114
    v_fma_f32 v132, v148, s74, v132
    v_fma_f32 v133, v149, s74, v133
    v_fma_f32 v134, v150, s74, v134
    v_fma_f32 v135, v151, s74, v135
    v_fma_f32 v148, v144, v44, v228
    v_fma_f32 v149, v145, v45, v229
    v_fma_f32 v150, v146, v46, v230
    v_fma_f32 v151, v147, v47, v231
    v_fma_f32 v132, v148, v132, v144
    v_fma_f32 v133, v149, v133, v145
    v_fma_f32 v134, v150, v134, v146
    v_fma_f32 v135, v151, v135, v147
    v_cvt_pk_bf16_f32 v154, v132, v133
    v_cvt_pk_bf16_f32 v155, v134, v135
    buffer_store_dwordx2 v[154:155], v20, s[32:35], 0 offen offset:512
    v_lshlrev_b32 v144, 16, v36
    v_and_b32 v145, 0xffff0000, v36
    v_lshlrev_b32 v146, 16, v37
    v_and_b32 v147, 0xffff0000, v37
    v_and_b32 v148, 0xffff0000, v117
    v_lshlrev_b32 v149, 16, v117
    v_and_b32 v150, 0xffff0000, v116
    v_lshlrev_b32 v151, 16, v116
    v_fma_f32 v136, v148, s74, v136
    v_fma_f32 v137, v149, s74, v137
    v_fma_f32 v138, v150, s74, v138
    v_fma_f32 v139, v151, s74, v139
    v_fma_f32 v148, v144, v48, v232
    v_fma_f32 v149, v145, v49, v233
    v_fma_f32 v150, v146, v50, v234
    v_fma_f32 v151, v147, v51, v235
    v_fma_f32 v136, v148, v136, v144
    v_fma_f32 v137, v149, v137, v145
    v_fma_f32 v138, v150, v138, v146
    v_fma_f32 v139, v151, v139, v147
    v_cvt_pk_bf16_f32 v156, v136, v137
    v_cvt_pk_bf16_f32 v157, v138, v139
    buffer_store_dwordx2 v[156:157], v20, s[32:35], 0 offen offset:1024
    v_lshlrev_b32 v144, 16, v38
    v_and_b32 v145, 0xffff0000, v38
    v_lshlrev_b32 v146, 16, v39
    v_and_b32 v147, 0xffff0000, v39
    v_and_b32 v148, 0xffff0000, v119
    v_lshlrev_b32 v149, 16, v119
    v_and_b32 v150, 0xffff0000, v118
    v_lshlrev_b32 v151, 16, v118
    v_fma_f32 v140, v148, s74, v140
    v_fma_f32 v141, v149, s74, v141
    v_fma_f32 v142, v150, s74, v142
    v_fma_f32 v143, v151, s74, v143
    v_fma_f32 v148, v144, v52, v236
    v_fma_f32 v149, v145, v53, v237
    v_fma_f32 v150, v146, v54, v238
    v_fma_f32 v151, v147, v55, v239
    v_fma_f32 v140, v148, v140, v144
    v_fma_f32 v141, v149, v141, v145
    v_fma_f32 v142, v150, v142, v146
    v_fma_f32 v143, v151, v143, v147
    v_cvt_pk_bf16_f32 v158, v140, v141
    v_cvt_pk_bf16_f32 v159, v142, v143
    buffer_store_dwordx2 v[158:159], v20, s[32:35], 0 offen offset:1536
KA_END:
    s_endpgm
KA_CODE_END:

.globl kb_kernel
.p2align 8
.type kb_kernel,@function
kb_kernel:
    s_cmp_ge_u32 s2, 256
    s_cbranch_scc1 KB_END
    s_load_dwordx4 s[4:7], s[0:1], 64
    s_load_dwordx2 s[8:9], s[0:1], 88
    s_load_dwordx2 s[12:13], s[0:1], 104
    v_lshrrev_b32 v1, 6, v0
    s_nop 0
    v_readfirstlane_b32 s50, v1
    v_and_b32 v2, 63, v0
    v_lshlrev_b32 v4, 4, v2
    v_and_b32 v5, 31, v2
    v_lshrrev_b32 v6, 5, v2
    v_lshrrev_b32 v9, 4, v2
    v_and_b32 v10, 15, v2
    s_and_b32 s70, s2, 7
    s_lshr_b32 s71, s2, 3
    s_lshr_b32 s72, s70, 1
    s_and_b32 s73, s70, 1
    s_lshl_b32 s72, s72, 3
    s_and_b32 s74, s71, 7
    s_add_u32 s75, s72, s74
    s_lshr_b32 s76, s71, 3
    s_lshl_b32 s77, s73, 2
    s_add_u32 s76, s76, s77
    s_mov_b32 s51, s75
    s_mov_b32 s52, s76
    s_cmp_lt_u32 s71, 24
    s_cbranch_scc1 KB_ID
    s_sub_u32 s51, s71, 24
    s_add_u32 s51, s51, s77
    s_add_u32 s51, s51, s72
    s_mov_b32 s52, 3
KB_ID:
    s_waitcnt lgkmcnt(0)
    s_add_u32 s36, s12, 4390912
    s_addc_u32 s37, s13, 0
    s_mov_b32 s38, 8192
    s_mov_b32 s39, 0x00020000
    s_cmp_ge_u32 s71, 28
    s_cbranch_scc1 KB_HELP
    s_lshl_b32 s53, s52, 2
    s_add_u32 s53, s53, s50
    s_add_u32 s54, s53, 28
    s_lshl_b32 s55, s51, 7
    s_lshl_b32 s56, s54, 15
    s_lshl_b32 s57, s53, 15
    s_and_b32 s58, s50, 1
    s_add_u32 s16, s12, 5242880
    s_addc_u32 s17, s13, 0
    s_add_u32 s16, s16, s55
    s_addc_u32 s17, s17, 0
    s_mov_b32 s18, 2162688
    s_mov_b32 s19, 0x00020000
    s_sub_u32 s18, s18, s55
    s_add_u32 s20, s12, 8388608
    s_addc_u32 s21, s13, 0
    s_add_u32 s20, s20, s56
    s_addc_u32 s21, s21, 0
    s_mov_b32 s22, 32768
    s_mov_b32 s23, 0x00020000
    s_add_u32 s24, s12, 8388608
    s_addc_u32 s25, s13, 0
    s_add_u32 s24, s24, s57
    s_addc_u32 s25, s25, 0
    s_mov_b32 s26, 32768
    s_mov_b32 s27, 0x00020000
    s_add_u32 s28, s12, 4456448
    s_addc_u32 s29, s13, 0
    s_mov_b32 s30, 57344
    s_mov_b32 s31, 0x00020000
    v_lshrrev_b32 v3, 3, v2
    v_mul_u32_u24 v3, 4224, v3
    v_and_b32 v7, 7, v2
    v_and_b32 v8, 1, v9
    v_lshlrev_b32 v8, 2, v8
    v_xor_b32 v7, v7, v8
    v_lshlrev_b32 v7, 4, v7
    v_add_u32 v3, v3, v7
    s_and_b32 s48, s70, 7
    s_lshl_b32 s49, s48, 3
    s_add_u32 s49, s49, s50
    s_lshl_b32 s60, s50, 10
    s_add_u32 m0, s60, 0
    s_mul_i32 s59, s49, 33792
    buffer_load_dwordx4 v3, s[16:19], s59 offen lds
    s_add_u32 s49, s49, 4
    s_and_b32 s49, s49, 63
    v_mul_u32_u24 v7, 28672, v6
    v_lshlrev_b32 v8, 2, v5
    v_add_u32 v7, v7, v8
    s_lshl_b32 s63, s53, 7
    v_add_u32 v7, s63, v7
    v_add_u32 v8, 3584, v7
    v_lshrrev_b32 v11, 1, v9
    v_lshlrev_b32 v11, 3, v11
    s_add_u32 s61, s48, 0
    s_and_b32 s61, s61, 7
    s_lshl_b32 s61, s61, 12
    buffer_load_dwordx4 a[0:3], v4, s[20:23], s61 offen offset:0
    v_lshrrev_b32 v12, 2, v10
    v_add_u32 v11, v11, v12
    v_lshlrev_b32 v11, 7, v11
    v_and_b32 v12, 1, v9
    v_lshlrev_b32 v12, 5, v12
    v_and_b32 v13, 3, v10
    v_lshlrev_b32 v13, 3, v13
    v_add3_u32 v11, v11, v12, v13
    buffer_load_dwordx4 a[4:7], v4, s[20:23], s61 offen offset:1024
    v_lshrrev_b32 v12, 3, v10
    v_xor_b32 v12, s58, v12
    v_lshlrev_b32 v12, 6, v12
    v_add_u32 v14, v11, v12
    v_xor_b32 v15, 64, v14
    v_mov_b32 v26, 0xc0135761
    v_mov_b32 v27, 0xc0135761
    v_mov_b32 v28, 0xbdd2d3e8
    s_add_u32 m0, s60, 4096
    s_mul_i32 s59, s49, 33792
    buffer_load_dwordx4 v3, s[16:19], s59 offen lds
    s_add_u32 s49, s49, 4
    s_and_b32 s49, s49, 63
    v_mov_b32 v29, 0xbdd2d3e8
    v_mov_b32 v30, 1.0
    v_mov_b32 v31, 1.0
    v_mov_b32 v216, 0x3f803f80
    v_mov_b32 v217, 0x3f803f80
    v_mov_b32 v218, 0x3f803f80
    v_mov_b32 v219, 0x3f803f80
    v_mov_b32 v17, 0
    buffer_load_dwordx4 a[8:11], v4, s[20:23], s61 offen offset:2048
    s_lshr_b32 s64, s50, 1
    s_lshl_b32 s65, s51, 18
    s_lshl_b32 s66, s58, 17
    s_add_u32 s65, s65, s66
    s_lshl_b32 s66, s64, 11
    s_add_u32 s65, s65, s66
    s_add_u32 s44, s4, s65
    s_addc_u32 s45, s5, 0
    buffer_load_dwordx4 a[12:15], v4, s[20:23], s61 offen offset:3072
    s_mov_b32 s46, 131072
    s_mov_b32 s47, 0x00020000
    s_lshl_b32 s66, s64, 11
    s_sub_u32 s46, s46, s66
    v_lshrrev_b32 v234, 3, v2
    v_lshlrev_b32 v234, 12, v234
    v_and_b32 v235, 7, v2
    v_xor_b32 v235, v235, v9
    s_add_u32 m0, s60, 8192
    s_mul_i32 s59, s49, 33792
    buffer_load_dwordx4 v3, s[16:19], s59 offen lds
    s_add_u32 s49, s49, 4
    s_and_b32 s49, s49, 63
    v_lshlrev_b32 v235, 4, v235
    v_add_u32 v234, v234, v235
    v_xor_b32 v235, 64, v234
    v_add_u32 v235, 0x8000, v235
    v_add_u32 v116, 0x10000, v234
    v_add_u32 v117, 0x10000, v235
    v_lshrrev_b32 v220, 1, v5
    v_and_b32 v220, 7, v220
    s_add_u32 s61, s48, 1
    s_and_b32 s61, s61, 7
    s_lshl_b32 s61, s61, 12
    buffer_load_dwordx4 a[16:19], v4, s[20:23], s61 offen offset:0
    v_xor_b32 v220, v220, v6
    v_lshlrev_b32 v232, 7, v5
    s_mul_i32 s72, s50, 12288
    s_add_u32 s72, s72, 65536
    s_lshl_b32 s73, s50, 13
    s_add_u32 s73, s73, 118784
    s_lshl_b32 s74, s50, 14
    v_xor_b32 v233, 0, v220
    buffer_load_dwordx4 a[20:23], v4, s[20:23], s61 offen offset:1024
    v_lshlrev_b32 v233, 4, v233
    v_add_u32 v233, v232, v233
    v_add_u32 v224, s72, v233
    v_add_u32 v228, s73, v233
    v_add_u32 v236, s74, v233
    v_xor_b32 v233, 2, v220
    v_lshlrev_b32 v233, 4, v233
    v_add_u32 v233, v232, v233
    s_add_u32 m0, s60, 12288
    s_mul_i32 s59, s49, 33792
    buffer_load_dwordx4 v3, s[16:19], s59 offen lds
    s_add_u32 s49, s49, 4
    s_and_b32 s49, s49, 63
    v_add_u32 v225, s72, v233
    v_add_u32 v229, s73, v233
    v_add_u32 v237, s74, v233
    v_xor_b32 v233, 4, v220
    v_lshlrev_b32 v233, 4, v233
    v_add_u32 v233, v232, v233
    v_add_u32 v226, s72, v233
    v_add_u32 v230, s73, v233
    buffer_load_dwordx4 a[24:27], v4, s[20:23], s61 offen offset:2048
    v_add_u32 v238, s74, v233
    v_xor_b32 v233, 6, v220
    v_lshlrev_b32 v233, 4, v233
    v_add_u32 v233, v232, v233
    v_add_u32 v227, s72, v233
    v_add_u32 v231, s73, v233
    v_add_u32 v239, s74, v233
    s_mov_b32 s67, 0
    buffer_load_dwordx4 a[28:31], v4, s[20:23], s61 offen offset:3072
    s_lshl_b32 s68, s67, 7
    s_lshl_b32 s80, s50, 12
    s_add_u32 s80, s80, 118784
    v_lshrrev_b32 v192, 1, v2
    v_and_b32 v192, 7, v192
    v_xor_b32 v192, v192, v6
    s_lshl_b32 s81, s58, 11
    s_add_u32 s81, s81, s80
    s_add_u32 m0, s60, 16384
    s_mul_i32 s59, s49, 33792
    buffer_load_dwordx4 v3, s[16:19], s59 offen lds
    s_add_u32 s49, s49, 4
    s_and_b32 s49, s49, 63
    v_lshlrev_b32 v193, 6, v5
    v_add_u32 v193, s81, v193
    v_xor_b32 v194, 0, v192
    v_lshlrev_b32 v194, 3, v194
    v_add_u32 v240, v193, v194
    v_xor_b32 v244, 2048, v240
    v_xor_b32 v194, 2, v192
    v_lshlrev_b32 v194, 3, v194
    s_add_u32 s61, s48, 2
    s_and_b32 s61, s61, 7
    s_lshl_b32 s61, s61, 12
    buffer_load_dwordx4 a[32:35], v4, s[20:23], s61 offen offset:0
    v_add_u32 v241, v193, v194
    v_xor_b32 v245, 2048, v241
    v_xor_b32 v194, 4, v192
    v_lshlrev_b32 v194, 3, v194
    v_add_u32 v242, v193, v194
    v_xor_b32 v246, 2048, v242
    v_xor_b32 v194, 6, v192
    v_lshlrev_b32 v194, 3, v194
    buffer_load_dwordx4 a[36:39], v4, s[20:23], s61 offen offset:1024
    v_add_u32 v243, v193, v194
    v_xor_b32 v247, 2048, v243
    v_lshrrev_b32 v196, 1, v9
    v_lshlrev_b32 v197, 3, v196
    v_lshrrev_b32 v198, 2, v10
    v_add_u32 v197, v197, v198
    v_lshlrev_b32 v197, 6, v197
    v_add_u32 v197, s80, v197
    s_add_u32 m0, s60, 20480
    s_mul_i32 s59, s49, 33792
    buffer_load_dwordx4 v3, s[16:19], s59 offen lds
    s_add_u32 s49, s49, 4
    s_and_b32 s49, s49, 63
    v_and_b32 v198, 1, v9
    v_lshlrev_b32 v198, 2, v198
    v_and_b32 v199, 3, v10
    v_add_u32 v198, v198, v199
    v_lshlrev_b32 v196, 2, v196
    v_lshrrev_b32 v199, 3, v10
    v_add_u32 v196, v196, v199
    v_xor_b32 v248, v198, v196
    buffer_load_dwordx4 a[40:43], v4, s[20:23], s61 offen offset:2048
    v_lshlrev_b32 v248, 3, v248
    v_add_u32 v248, v197, v248
    v_add_u32 v196, 2, v196
    v_and_b32 v196, 7, v196
    v_xor_b32 v249, v198, v196
    v_lshlrev_b32 v249, 3, v249
    v_add_u32 v249, v197, v249
    v_add_u32 v249, 256, v249
    buffer_load_dwordx4 a[44:47], v4, s[20:23], s61 offen offset:3072
    s_add_u32 s32, s12, 4259840
    s_addc_u32 s33, s13, 0
    s_mov_b32 s34, 131072
    s_mov_b32 s35, 0x00020000
    s_lshl_b32 s69, s51, 12
    v_lshlrev_b32 v250, 3, v2
    v_add_u32 v250, s69, v250
    s_lshl_b32 s82, s53, 17
    s_add_u32 m0, s60, 24576
    s_mul_i32 s59, s49, 33792
    buffer_load_dwordx4 v3, s[16:19], s59 offen lds
    s_add_u32 s49, s49, 4
    s_and_b32 s49, s49, 63
    s_add_u32 s40, s12, 15728640
    s_addc_u32 s41, s13, 0
    s_add_u32 s40, s40, s82
    s_addc_u32 s41, s41, 0
    s_mov_b32 s42, 131072
    s_mov_b32 s43, 0x00020000
    s_lshl_b32 s83, s51, 12
    s_lshr_b32 s80, s50, 1
    s_add_u32 s61, s48, 3
    s_and_b32 s61, s61, 7
    s_lshl_b32 s61, s61, 12
    buffer_load_dwordx4 a[48:51], v4, s[20:23], s61 offen offset:0
    s_lshl_b32 s80, s80, 8
    s_lshl_b32 s81, s58, 7
    s_add_u32 s69, s80, s81
    s_add_u32 s69, s69, 114688
    v_lshlrev_b32 v22, 2, v5
    v_add_u32 v251, s69, v22
    s_add_u32 s69, s81, 114688
    v_add_u32 v252, s69, v22
    buffer_load_dwordx4 a[52:55], v4, s[20:23], s61 offen offset:1024
    v_lshrrev_b32 v21, 2, v5
    v_and_b32 v21, 1, v21
    v_cmp_eq_u32 vcc, v21, v6
    s_cmp_lt_u32 s50, 2
    s_cselect_b64 s[78:79], -1, 0
    s_or_b64 vcc, vcc, s[78:79]
    s_lshl_b32 s69, s50, 12
    s_add_u32 s69, s69, 118784
    s_add_u32 m0, s60, 28672
    s_mul_i32 s59, s49, 33792
    buffer_load_dwordx4 v3, s[16:19], s59 offen lds
    s_add_u32 s49, s49, 4
    s_and_b32 s49, s49, 63
    v_lshlrev_b32 v21, 2, v2
    v_add_u32 v23, s69, v21
    v_cndmask_b32 v251, v23, v251, vcc
    s_lshl_b32 s69, s50, 8
    s_add_u32 s69, s69, 117248
    v_add_u32 v253, s69, v21
    v_lshlrev_b32 v21, 4, v6
    v_add_u32 v254, s69, v21
    buffer_load_dwordx4 a[56:59], v4, s[20:23], s61 offen offset:2048
    v_lshlrev_b32 v22, 3, v5
    v_and_b32 v112, 1, v5
    v_and_b32 v113, 2, v5
    v_and_b32 v114, 8, v5
    v_and_b32 v115, 16, v5
    s_lshl_b32 s69, s52, 7
    s_lshl_b32 s80, s51, 2
    s_add_u32 s69, s69, s80
    buffer_load_dwordx4 a[60:63], v4, s[20:23], s61 offen offset:3072
    v_mov_b32 v255, s69
    v_mov_b32 v21, 0x7fffffff
    v_cmp_eq_u32 vcc, 0, v2
    s_nop 1
    v_cndmask_b32 v255, v21, v255, vcc
    s_mov_b32 s65, 0x3b000000
    s_mov_b32 s66, 0x3727c5ac
    s_cmp_ge_u32 s50, 2
    s_cbranch_scc1 KB_P1G
    s_waitcnt vmcnt(12)
    s_barrier
    ds_read_b64_tr_b16 v[96:97], v14 offset:0
    ds_read_b64_tr_b16 v[98:99], v14 offset:512
    ds_read_b64_tr_b16 v[100:101], v15 offset:0
    ds_read_b64_tr_b16 v[102:103], v15 offset:512
    s_waitcnt lgkmcnt(2)
    v_mfma_f32_32x32x16_bf16 v[32:47], a[0:3], v[96:99], 0
    ds_read_b64_tr_b16 v[104:105], v14 offset:2048
    ds_read_b64_tr_b16 v[106:107], v14 offset:2560
    s_add_u32 m0, s60, 32768
    s_mul_i32 s59, s49, 33792
    buffer_load_dwordx4 v3, s[16:19], s59 offen lds
    s_add_u32 s49, s49, 4
    s_and_b32 s49, s49, 63
    v_mfma_f32_32x32x16_bf16 v[200:215], v[216:219], v[96:99], 0
    s_waitcnt lgkmcnt(2)
    s_add_u32 s61, s48, 4
    s_and_b32 s61, s61, 7
    s_lshl_b32 s61, s61, 12
    buffer_load_dwordx4 a[64:67], v4, s[20:23], s61 offen offset:0
    v_mfma_f32_32x32x16_bf16 v[48:63], a[0:3], v[100:103], 0
    ds_read_b64_tr_b16 v[108:109], v15 offset:2048
    ds_read_b64_tr_b16 v[110:111], v15 offset:2560
    s_waitcnt lgkmcnt(2)
    v_mfma_f32_32x32x16_bf16 v[32:47], a[4:7], v[104:107], v[32:47]
    ds_read_b64_tr_b16 v[96:97], v14 offset:4096
    ds_read_b64_tr_b16 v[98:99], v14 offset:4608
    buffer_load_dwordx4 a[68:71], v4, s[20:23], s61 offen offset:1024
    v_mfma_f32_32x32x16_bf16 v[200:215], v[216:219], v[104:107], v[200:215]
    s_waitcnt lgkmcnt(2)
    v_mfma_f32_32x32x16_bf16 v[48:63], a[4:7], v[108:111], v[48:63]
    ds_read_b64_tr_b16 v[100:101], v15 offset:4096
    ds_read_b64_tr_b16 v[102:103], v15 offset:4608
    s_waitcnt lgkmcnt(2)
    v_mfma_f32_32x32x16_bf16 v[32:47], a[8:11], v[96:99], v[32:47]
    ds_read_b64_tr_b16 v[104:105], v14 offset:6144
    ds_read_b64_tr_b16 v[106:107], v14 offset:6656
    s_add_u32 m0, s60, 36864
    s_mul_i32 s59, s49, 33792
    buffer_load_dwordx4 v3, s[16:19], s59 offen lds
    s_add_u32 s49, s49, 4
    s_and_b32 s49, s49, 63
    v_mfma_f32_32x32x16_bf16 v[200:215], v[216:219], v[96:99], v[200:215]
    s_waitcnt lgkmcnt(2)
    buffer_load_dwordx4 a[72:75], v4, s[20:23], s61 offen offset:2048
    v_mfma_f32_32x32x16_bf16 v[48:63], a[8:11], v[100:103], v[48:63]
    ds_read_b64_tr_b16 v[108:109], v15 offset:6144
    ds_read_b64_tr_b16 v[110:111], v15 offset:6656
    s_waitcnt lgkmcnt(2)
    v_mfma_f32_32x32x16_bf16 v[32:47], a[12:15], v[104:107], v[32:47]
    ds_read_b64_tr_b16 v[96:97], v14 offset:8192
    ds_read_b64_tr_b16 v[98:99], v14 offset:8704
    buffer_load_dwordx4 a[76:79], v4, s[20:23], s61 offen offset:3072
    v_mfma_f32_32x32x16_bf16 v[200:215], v[216:219], v[104:107], v[200:215]
    s_waitcnt lgkmcnt(2)
    v_mfma_f32_32x32x16_bf16 v[48:63], a[12:15], v[108:111], v[48:63]
    ds_read_b64_tr_b16 v[100:101], v15 offset:8192
    ds_read_b64_tr_b16 v[102:103], v15 offset:8704
    s_waitcnt lgkmcnt(2)
    v_mfma_f32_32x32x16_bf16 v[32:47], a[16:19], v[96:99], v[32:47]
    ds_read_b64_tr_b16 v[104:105], v14 offset:10240
    ds_read_b64_tr_b16 v[106:107], v14 offset:10752
    s_add_u32 m0, s60, 40960
    s_mul_i32 s59, s49, 33792
    buffer_load_dwordx4 v3, s[16:19], s59 offen lds
    s_add_u32 s49, s49, 4
    s_and_b32 s49, s49, 63
    v_mfma_f32_32x32x16_bf16 v[200:215], v[216:219], v[96:99], v[200:215]
    s_waitcnt lgkmcnt(2)
    s_add_u32 s61, s48, 5
    s_and_b32 s61, s61, 7
    s_lshl_b32 s61, s61, 12
    buffer_load_dwordx4 a[80:83], v4, s[20:23], s61 offen offset:0
    v_mfma_f32_32x32x16_bf16 v[48:63], a[16:19], v[100:103], v[48:63]
    ds_read_b64_tr_b16 v[108:109], v15 offset:10240
    ds_read_b64_tr_b16 v[110:111], v15 offset:10752
    s_waitcnt lgkmcnt(2)
    v_mfma_f32_32x32x16_bf16 v[32:47], a[20:23], v[104:107], v[32:47]
    ds_read_b64_tr_b16 v[96:97], v14 offset:12288
    ds_read_b64_tr_b16 v[98:99], v14 offset:12800
    buffer_load_dwordx4 a[84:87], v4, s[20:23], s61 offen offset:1024
    v_mfma_f32_32x32x16_bf16 v[200:215], v[216:219], v[104:107], v[200:215]
    s_waitcnt lgkmcnt(2)
    v_mfma_f32_32x32x16_bf16 v[48:63], a[20:23], v[108:111], v[48:63]
    ds_read_b64_tr_b16 v[100:101], v15 offset:12288
    ds_read_b64_tr_b16 v[102:103], v15 offset:12800
    s_waitcnt lgkmcnt(2)
    v_mfma_f32_32x32x16_bf16 v[32:47], a[24:27], v[96:99], v[32:47]
    ds_read_b64_tr_b16 v[104:105], v14 offset:14336
    ds_read_b64_tr_b16 v[106:107], v14 offset:14848
    s_add_u32 m0, s60, 45056
    s_mul_i32 s59, s49, 33792
    buffer_load_dwordx4 v3, s[16:19], s59 offen lds
    s_add_u32 s49, s49, 4
    s_and_b32 s49, s49, 63
    v_mfma_f32_32x32x16_bf16 v[200:215], v[216:219], v[96:99], v[200:215]
    s_waitcnt lgkmcnt(2)
    buffer_load_dwordx4 a[88:91], v4, s[20:23], s61 offen offset:2048
    v_mfma_f32_32x32x16_bf16 v[48:63], a[24:27], v[100:103], v[48:63]
    ds_read_b64_tr_b16 v[108:109], v15 offset:14336
    ds_read_b64_tr_b16 v[110:111], v15 offset:14848
    s_waitcnt vmcnt(11)
    s_barrier
    s_waitcnt lgkmcnt(2)
    v_mfma_f32_32x32x16_bf16 v[32:47], a[28:31], v[104:107], v[32:47]
    ds_read_b64_tr_b16 v[96:97], v14 offset:16384
    ds_read_b64_tr_b16 v[98:99], v14 offset:16896
    buffer_load_dwordx4 a[92:95], v4, s[20:23], s61 offen offset:3072
    v_mfma_f32_32x32x16_bf16 v[200:215], v[216:219], v[104:107], v[200:215]
    s_waitcnt lgkmcnt(2)
    v_mfma_f32_32x32x16_bf16 v[48:63], a[28:31], v[108:111], v[48:63]
    ds_read_b64_tr_b16 v[100:101], v15 offset:16384
    ds_read_b64_tr_b16 v[102:103], v15 offset:16896
    s_waitcnt lgkmcnt(2)
    v_mfma_f32_32x32x16_bf16 v[32:47], a[32:35], v[96:99], v[32:47]
    ds_read_b64_tr_b16 v[104:105], v14 offset:18432
    ds_read_b64_tr_b16 v[106:107], v14 offset:18944
    s_add_u32 m0, s60, 49152
    s_mul_i32 s59, s49, 33792
    buffer_load_dwordx4 v3, s[16:19], s59 offen lds
    s_add_u32 s49, s49, 4
    s_and_b32 s49, s49, 63
    v_mfma_f32_32x32x16_bf16 v[200:215], v[216:219], v[96:99], v[200:215]
    s_waitcnt lgkmcnt(2)
    s_add_u32 s61, s48, 6
    s_and_b32 s61, s61, 7
    s_lshl_b32 s61, s61, 12
    buffer_load_dwordx4 a[96:99], v4, s[20:23], s61 offen offset:0
    v_mfma_f32_32x32x16_bf16 v[48:63], a[32:35], v[100:103], v[48:63]
    ds_read_b64_tr_b16 v[108:109], v15 offset:18432
    ds_read_b64_tr_b16 v[110:111], v15 offset:18944
    s_waitcnt lgkmcnt(2)
    v_mfma_f32_32x32x16_bf16 v[32:47], a[36:39], v[104:107], v[32:47]
    ds_read_b64_tr_b16 v[96:97], v14 offset:20480
    ds_read_b64_tr_b16 v[98:99], v14 offset:20992
    buffer_load_dwordx4 a[100:103], v4, s[20:23], s61 offen offset:1024
    v_mfma_f32_32x32x16_bf16 v[200:215], v[216:219], v[104:107], v[200:215]
    s_waitcnt lgkmcnt(2)
    v_mfma_f32_32x32x16_bf16 v[48:63], a[36:39], v[108:111], v[48:63]
    ds_read_b64_tr_b16 v[100:101], v15 offset:20480
    ds_read_b64_tr_b16 v[102:103], v15 offset:20992
    s_waitcnt lgkmcnt(2)
    v_mfma_f32_32x32x16_bf16 v[32:47], a[40:43], v[96:99], v[32:47]
    ds_read_b64_tr_b16 v[104:105], v14 offset:22528
    ds_read_b64_tr_b16 v[106:107], v14 offset:23040
    s_add_u32 m0, s60, 53248
    s_mul_i32 s59, s49, 33792
    buffer_load_dwordx4 v3, s[16:19], s59 offen lds
    s_add_u32 s49, s49, 4
    s_and_b32 s49, s49, 63
    v_mfma_f32_32x32x16_bf16 v[200:215], v[216:219], v[96:99], v[200:215]
    s_waitcnt lgkmcnt(2)
    buffer_load_dwordx4 a[104:107], v4, s[20:23], s61 offen offset:2048
    v_mfma_f32_32x32x16_bf16 v[48:63], a[40:43], v[100:103], v[48:63]
    ds_read_b64_tr_b16 v[108:109], v15 offset:22528
    ds_read_b64_tr_b16 v[110:111], v15 offset:23040
    s_waitcnt lgkmcnt(2)
    v_mfma_f32_32x32x16_bf16 v[32:47], a[44:47], v[104:107], v[32:47]
    ds_read_b64_tr_b16 v[96:97], v14 offset:24576
    ds_read_b64_tr_b16 v[98:99], v14 offset:25088
    buffer_load_dwordx4 a[108:111], v4, s[20:23], s61 offen offset:3072
    v_mfma_f32_32x32x16_bf16 v[200:215], v[216:219], v[104:107], v[200:215]
    s_waitcnt lgkmcnt(2)
    v_mfma_f32_32x32x16_bf16 v[48:63], a[44:47], v[108:111], v[48:63]
    ds_read_b64_tr_b16 v[100:101], v15 offset:24576
    ds_read_b64_tr_b16 v[102:103], v15 offset:25088
    s_waitcnt lgkmcnt(2)
    v_mfma_f32_32x32x16_bf16 v[32:47], a[48:51], v[96:99], v[32:47]
    ds_read_b64_tr_b16 v[104:105], v14 offset:26624
    ds_read_b64_tr_b16 v[106:107], v14 offset:27136
    s_add_u32 m0, s60, 57344
    s_mul_i32 s59, s49, 33792
    buffer_load_dwordx4 v3, s[16:19], s59 offen lds
    s_add_u32 s49, s49, 4
    s_and_b32 s49, s49, 63
    v_mfma_f32_32x32x16_bf16 v[200:215], v[216:219], v[96:99], v[200:215]
    s_waitcnt lgkmcnt(2)
    s_add_u32 s61, s48, 7
    s_and_b32 s61, s61, 7
    s_lshl_b32 s61, s61, 12
    buffer_load_dwordx4 a[112:115], v4, s[20:23], s61 offen offset:0
    v_mfma_f32_32x32x16_bf16 v[48:63], a[48:51], v[100:103], v[48:63]
    ds_read_b64_tr_b16 v[108:109], v15 offset:26624
    ds_read_b64_tr_b16 v[110:111], v15 offset:27136
    s_waitcnt lgkmcnt(2)
    v_mfma_f32_32x32x16_bf16 v[32:47], a[52:55], v[104:107], v[32:47]
    ds_read_b64_tr_b16 v[96:97], v14 offset:28672
    ds_read_b64_tr_b16 v[98:99], v14 offset:29184
    buffer_load_dwordx4 a[116:119], v4, s[20:23], s61 offen offset:1024
    v_mfma_f32_32x32x16_bf16 v[200:215], v[216:219], v[104:107], v[200:215]
    s_waitcnt lgkmcnt(2)
    v_mfma_f32_32x32x16_bf16 v[48:63], a[52:55], v[108:111], v[48:63]
    ds_read_b64_tr_b16 v[100:101], v15 offset:28672
    ds_read_b64_tr_b16 v[102:103], v15 offset:29184
    s_waitcnt lgkmcnt(2)
    v_mfma_f32_32x32x16_bf16 v[32:47], a[56:59], v[96:99], v[32:47]
    ds_read_b64_tr_b16 v[104:105], v14 offset:30720
    ds_read_b64_tr_b16 v[106:107], v14 offset:31232
    s_add_u32 m0, s60, 61440
    s_mul_i32 s59, s49, 33792
    buffer_load_dwordx4 v3, s[16:19], s59 offen lds
    s_add_u32 s49, s49, 4
    s_and_b32 s49, s49, 63
    v_mfma_f32_32x32x16_bf16 v[200:215], v[216:219], v[96:99], v[200:215]
    s_waitcnt lgkmcnt(2)
    buffer_load_dwordx4 a[120:123], v4, s[20:23], s61 offen offset:2048
    v_mfma_f32_32x32x16_bf16 v[48:63], a[56:59], v[100:103], v[48:63]
    ds_read_b64_tr_b16 v[108:109], v15 offset:30720
    ds_read_b64_tr_b16 v[110:111], v15 offset:31232
    s_waitcnt vmcnt(11)
    s_barrier
    s_waitcnt lgkmcnt(2)
    v_mfma_f32_32x32x16_bf16 v[32:47], a[60:63], v[104:107], v[32:47]
    ds_read_b64_tr_b16 v[96:97], v14 offset:32768
    ds_read_b64_tr_b16 v[98:99], v14 offset:33280
    buffer_load_dwordx4 a[124:127], v4, s[20:23], s61 offen offset:3072
    v_mfma_f32_32x32x16_bf16 v[200:215], v[216:219], v[104:107], v[200:215]
    s_waitcnt lgkmcnt(2)
    v_mfma_f32_32x32x16_bf16 v[48:63], a[60:63], v[108:111], v[48:63]
    ds_read_b64_tr_b16 v[100:101], v15 offset:32768
    ds_read_b64_tr_b16 v[102:103], v15 offset:33280
    s_waitcnt lgkmcnt(2)
    v_mfma_f32_32x32x16_bf16 v[32:47], a[64:67], v[96:99], v[32:47]
    ds_read_b64_tr_b16 v[104:105], v14 offset:34816
    ds_read_b64_tr_b16 v[106:107], v14 offset:35328
    s_mov_b32 s63, 0
    buffer_load_dword v184, v8, s[28:31], s63 offen
    v_mfma_f32_32x32x16_bf16 v[200:215], v[216:219], v[96:99], v[200:215]
    s_waitcnt lgkmcnt(2)
    buffer_load_dword v188, v7, s[28:31], s63 offen
    v_mfma_f32_32x32x16_bf16 v[48:63], a[64:67], v[100:103], v[48:63]
    ds_read_b64_tr_b16 v[108:109], v15 offset:34816
    ds_read_b64_tr_b16 v[110:111], v15 offset:35328
    s_waitcnt lgkmcnt(2)
    v_mfma_f32_32x32x16_bf16 v[32:47], a[68:71], v[104:107], v[32:47]
    ds_read_b64_tr_b16 v[96:97], v14 offset:36864
    ds_read_b64_tr_b16 v[98:99], v14 offset:37376
    s_mov_b32 s63, 7168
    buffer_load_dword v185, v8, s[28:31], s63 offen
    v_mfma_f32_32x32x16_bf16 v[200:215], v[216:219], v[104:107], v[200:215]
    s_waitcnt lgkmcnt(2)
    v_mfma_f32_32x32x16_bf16 v[48:63], a[68:71], v[108:111], v[48:63]
    ds_read_b64_tr_b16 v[100:101], v15 offset:36864
    ds_read_b64_tr_b16 v[102:103], v15 offset:37376
    s_waitcnt lgkmcnt(2)
    v_mfma_f32_32x32x16_bf16 v[32:47], a[72:75], v[96:99], v[32:47]
    ds_read_b64_tr_b16 v[104:105], v14 offset:38912
    ds_read_b64_tr_b16 v[106:107], v14 offset:39424
    buffer_load_dword v189, v7, s[28:31], s63 offen
    v_mfma_f32_32x32x16_bf16 v[200:215], v[216:219], v[96:99], v[200:215]
    s_waitcnt lgkmcnt(2)
    s_mov_b32 s63, 14336
    buffer_load_dword v186, v8, s[28:31], s63 offen
    v_mfma_f32_32x32x16_bf16 v[48:63], a[72:75], v[100:103], v[48:63]
    ds_read_b64_tr_b16 v[108:109], v15 offset:38912
    ds_read_b64_tr_b16 v[110:111], v15 offset:39424
    s_waitcnt lgkmcnt(2)
    v_mfma_f32_32x32x16_bf16 v[32:47], a[76:79], v[104:107], v[32:47]
    ds_read_b64_tr_b16 v[96:97], v14 offset:40960
    ds_read_b64_tr_b16 v[98:99], v14 offset:41472
    buffer_load_dword v190, v7, s[28:31], s63 offen
    v_mfma_f32_32x32x16_bf16 v[200:215], v[216:219], v[104:107], v[200:215]
    s_waitcnt lgkmcnt(2)
    v_mfma_f32_32x32x16_bf16 v[48:63], a[76:79], v[108:111], v[48:63]
    ds_read_b64_tr_b16 v[100:101], v15 offset:40960
    ds_read_b64_tr_b16 v[102:103], v15 offset:41472
    s_waitcnt lgkmcnt(2)
    v_mfma_f32_32x32x16_bf16 v[32:47], a[80:83], v[96:99], v[32:47]
    ds_read_b64_tr_b16 v[104:105], v14 offset:43008
    ds_read_b64_tr_b16 v[106:107], v14 offset:43520
    s_mov_b32 s63, 21504
    buffer_load_dword v187, v8, s[28:31], s63 offen
    v_mfma_f32_32x32x16_bf16 v[200:215], v[216:219], v[96:99], v[200:215]
    s_waitcnt lgkmcnt(2)
    buffer_load_dword v191, v7, s[28:31], s63 offen
    v_mfma_f32_32x32x16_bf16 v[48:63], a[80:83], v[100:103], v[48:63]
    ds_read_b64_tr_b16 v[108:109], v15 offset:43008
    ds_read_b64_tr_b16 v[110:111], v15 offset:43520
    s_waitcnt lgkmcnt(2)
    v_mfma_f32_32x32x16_bf16 v[32:47], a[84:87], v[104:107], v[32:47]
    ds_read_b64_tr_b16 v[96:97], v14 offset:45056
    ds_read_b64_tr_b16 v[98:99], v14 offset:45568
    s_add_u32 s62, s48, 0
    s_and_b32 s62, s62, 7
    s_lshl_b32 s62, s62, 12
    buffer_load_dwordx4 a[128:131], v4, s[24:27], s62 offen offset:0
    v_mfma_f32_32x32x16_bf16 v[200:215], v[216:219], v[104:107], v[200:215]
    s_waitcnt lgkmcnt(2)
    v_mfma_f32_32x32x16_bf16 v[48:63], a[84:87], v[108:111], v[48:63]
    ds_read_b64_tr_b16 v[100:101], v15 offset:45056
    ds_read_b64_tr_b16 v[102:103], v15 offset:45568
    s_waitcnt lgkmcnt(2)
    v_mfma_f32_32x32x16_bf16 v[32:47], a[88:91], v[96:99], v[32:47]
    ds_read_b64_tr_b16 v[104:105], v14 offset:47104
    ds_read_b64_tr_b16 v[106:107], v14 offset:47616
    buffer_load_dwordx4 a[132:135], v4, s[24:27], s62 offen offset:1024
    v_mfma_f32_32x32x16_bf16 v[200:215], v[216:219], v[96:99], v[200:215]
    s_waitcnt lgkmcnt(2)
    buffer_load_dwordx4 a[136:139], v4, s[24:27], s62 offen offset:2048
    v_mfma_f32_32x32x16_bf16 v[48:63], a[88:91], v[100:103], v[48:63]
    ds_read_b64_tr_b16 v[108:109], v15 offset:47104
    ds_read_b64_tr_b16 v[110:111], v15 offset:47616
    s_waitcnt vmcnt(11)
    s_barrier
    s_waitcnt lgkmcnt(2)
    v_mfma_f32_32x32x16_bf16 v[32:47], a[92:95], v[104:107], v[32:47]
    ds_read_b64_tr_b16 v[96:97], v14 offset:49152
    ds_read_b64_tr_b16 v[98:99], v14 offset:49664
    buffer_load_dwordx4 a[140:143], v4, s[24:27], s62 offen offset:3072
    v_mfma_f32_32x32x16_bf16 v[200:215], v[216:219], v[104:107], v[200:215]
    s_waitcnt lgkmcnt(2)
    v_mfma_f32_32x32x16_bf16 v[48:63], a[92:95], v[108:111], v[48:63]
    ds_read_b64_tr_b16 v[100:101], v15 offset:49152
    ds_read_b64_tr_b16 v[102:103], v15 offset:49664
    s_waitcnt lgkmcnt(2)
    v_mfma_f32_32x32x16_bf16 v[32:47], a[96:99], v[96:99], v[32:47]
    ds_read_b64_tr_b16 v[104:105], v14 offset:51200
    ds_read_b64_tr_b16 v[106:107], v14 offset:51712
    s_add_u32 s62, s48, 1
    s_and_b32 s62, s62, 7
    s_lshl_b32 s62, s62, 12
    buffer_load_dwordx4 a[144:147], v4, s[24:27], s62 offen offset:0
    v_mfma_f32_32x32x16_bf16 v[200:215], v[216:219], v[96:99], v[200:215]
    s_waitcnt lgkmcnt(2)
    buffer_load_dwordx4 a[148:151], v4, s[24:27], s62 offen offset:1024
    v_mfma_f32_32x32x16_bf16 v[48:63], a[96:99], v[100:103], v[48:63]
    ds_read_b64_tr_b16 v[108:109], v15 offset:51200
    ds_read_b64_tr_b16 v[110:111], v15 offset:51712
    s_waitcnt lgkmcnt(2)
    v_mfma_f32_32x32x16_bf16 v[32:47], a[100:103], v[104:107], v[32:47]
    ds_read_b64_tr_b16 v[96:97], v14 offset:53248
    ds_read_b64_tr_b16 v[98:99], v14 offset:53760
    buffer_load_dwordx4 a[152:155], v4, s[24:27], s62 offen offset:2048
    v_mfma_f32_32x32x16_bf16 v[200:215], v[216:219], v[104:107], v[200:215]
    s_waitcnt lgkmcnt(2)
    v_mfma_f32_32x32x16_bf16 v[48:63], a[100:103], v[108:111], v[48:63]
    ds_read_b64_tr_b16 v[100:101], v15 offset:53248
    ds_read_b64_tr_b16 v[102:103], v15 offset:53760
    s_waitcnt lgkmcnt(2)
    v_mfma_f32_32x32x16_bf16 v[32:47], a[104:107], v[96:99], v[32:47]
    ds_read_b64_tr_b16 v[104:105], v14 offset:55296
    ds_read_b64_tr_b16 v[106:107], v14 offset:55808
    buffer_load_dwordx4 a[156:159], v4, s[24:27], s62 offen offset:3072
    v_mfma_f32_32x32x16_bf16 v[200:215], v[216:219], v[96:99], v[200:215]
    s_waitcnt lgkmcnt(2)
    s_add_u32 s62, s48, 2
    s_and_b32 s62, s62, 7
    s_lshl_b32 s62, s62, 12
    buffer_load_dwordx4 a[160:163], v4, s[24:27], s62 offen offset:0
    v_mfma_f32_32x32x16_bf16 v[48:63], a[104:107], v[100:103], v[48:63]
    ds_read_b64_tr_b16 v[108:109], v15 offset:55296
    ds_read_b64_tr_b16 v[110:111], v15 offset:55808
    s_waitcnt lgkmcnt(2)
    v_mfma_f32_32x32x16_bf16 v[32:47], a[108:111], v[104:107], v[32:47]
    ds_read_b64_tr_b16 v[96:97], v14 offset:57344
    ds_read_b64_tr_b16 v[98:99], v14 offset:57856
    buffer_load_dwordx4 a[164:167], v4, s[24:27], s62 offen offset:1024
    v_mfma_f32_32x32x16_bf16 v[200:215], v[216:219], v[104:107], v[200:215]
    s_waitcnt lgkmcnt(2)
    v_mfma_f32_32x32x16_bf16 v[48:63], a[108:111], v[108:111], v[48:63]
    ds_read_b64_tr_b16 v[100:101], v15 offset:57344
    ds_read_b64_tr_b16 v[102:103], v15 offset:57856
    s_waitcnt lgkmcnt(2)
    v_mfma_f32_32x32x16_bf16 v[32:47], a[112:115], v[96:99], v[32:47]
    ds_read_b64_tr_b16 v[104:105], v14 offset:59392
    ds_read_b64_tr_b16 v[106:107], v14 offset:59904
    buffer_load_dwordx4 a[168:171], v4, s[24:27], s62 offen offset:2048
    v_mfma_f32_32x32x16_bf16 v[200:215], v[216:219], v[96:99], v[200:215]
    s_waitcnt lgkmcnt(2)
    buffer_load_dwordx4 a[172:175], v4, s[24:27], s62 offen offset:3072
    v_mfma_f32_32x32x16_bf16 v[48:63], a[112:115], v[100:103], v[48:63]
    ds_read_b64_tr_b16 v[108:109], v15 offset:59392
    ds_read_b64_tr_b16 v[110:111], v15 offset:59904
    s_waitcnt lgkmcnt(2)
    v_mfma_f32_32x32x16_bf16 v[32:47], a[116:119], v[104:107], v[32:47]
    ds_read_b64_tr_b16 v[96:97], v14 offset:61440
    ds_read_b64_tr_b16 v[98:99], v14 offset:61952
    s_add_u32 s62, s48, 3
    s_and_b32 s62, s62, 7
    s_lshl_b32 s62, s62, 12
    buffer_load_dwordx4 a[176:179], v4, s[24:27], s62 offen offset:0
    v_mfma_f32_32x32x16_bf16 v[200:215], v[216:219], v[104:107], v[200:215]
    s_waitcnt lgkmcnt(2)
    v_mfma_f32_32x32x16_bf16 v[48:63], a[116:119], v[108:111], v[48:63]
    ds_read_b64_tr_b16 v[100:101], v15 offset:61440
    ds_read_b64_tr_b16 v[102:103], v15 offset:61952
    s_waitcnt lgkmcnt(2)
    v_mfma_f32_32x32x16_bf16 v[32:47], a[120:123], v[96:99], v[32:47]
    ds_read_b64_tr_b16 v[104:105], v14 offset:63488
    ds_read_b64_tr_b16 v[106:107], v14 offset:64000
    buffer_load_dwordx4 a[180:183], v4, s[24:27], s62 offen offset:1024
    v_mfma_f32_32x32x16_bf16 v[200:215], v[216:219], v[96:99], v[200:215]
    s_waitcnt lgkmcnt(2)
    buffer_load_dwordx4 a[184:187], v4, s[24:27], s62 offen offset:2048
    v_mfma_f32_32x32x16_bf16 v[48:63], a[120:123], v[100:103], v[48:63]
    ds_read_b64_tr_b16 v[108:109], v15 offset:63488
    ds_read_b64_tr_b16 v[110:111], v15 offset:64000
    s_waitcnt lgkmcnt(2)
    v_mfma_f32_32x32x16_bf16 v[32:47], a[124:127], v[104:107], v[32:47]
    buffer_load_dwordx4 a[188:191], v4, s[24:27], s62 offen offset:3072
    v_mfma_f32_32x32x16_bf16 v[200:215], v[216:219], v[104:107], v[200:215]
    s_waitcnt lgkmcnt(0)
    v_mfma_f32_32x32x16_bf16 v[48:63], a[124:127], v[108:111], v[48:63]
    s_nop 11
    v_mov_b32 v17, v200
    s_branch KB_P1J
KB_P1G:
    s_waitcnt vmcnt(12)
    s_barrier
    ds_read_b64_tr_b16 v[96:97], v14 offset:0
    ds_read_b64_tr_b16 v[98:99], v14 offset:512
    ds_read_b64_tr_b16 v[100:101], v15 offset:0
    ds_read_b64_tr_b16 v[102:103], v15 offset:512
    s_waitcnt lgkmcnt(2)
    v_mfma_f32_32x32x16_bf16 v[32:47], a[0:3], v[96:99], 0
    ds_read_b64_tr_b16 v[104:105], v14 offset:2048
    ds_read_b64_tr_b16 v[106:107], v14 offset:2560
    s_add_u32 m0, s60, 32768
    s_mul_i32 s59, s49, 33792
    buffer_load_dwordx4 v3, s[16:19], s59 offen lds
    s_add_u32 s49, s49, 4
    s_and_b32 s49, s49, 63
    v_mfma_f32_32x32x16_bf16 v[200:215], v[96:99], v[96:99], 0
    s_waitcnt lgkmcnt(2)
    s_add_u32 s61, s48, 4
    s_and_b32 s61, s61, 7
    s_lshl_b32 s61, s61, 12
    buffer_load_dwordx4 a[64:67], v4, s[20:23], s61 offen offset:0
    v_mfma_f32_32x32x16_bf16 v[48:63], a[0:3], v[100:103], 0
    ds_read_b64_tr_b16 v[108:109], v15 offset:2048
    ds_read_b64_tr_b16 v[110:111], v15 offset:2560
    s_waitcnt lgkmcnt(2)
    v_mfma_f32_32x32x16_bf16 v[32:47], a[4:7], v[104:107], v[32:47]
    ds_read_b64_tr_b16 v[96:97], v14 offset:4096
    ds_read_b64_tr_b16 v[98:99], v14 offset:4608
    buffer_load_dwordx4 a[68:71], v4, s[20:23], s61 offen offset:1024
    v_mfma_f32_32x32x16_bf16 v[200:215], v[104:107], v[104:107], v[200:215]
    s_waitcnt lgkmcnt(2)
    v_mfma_f32_32x32x16_bf16 v[48:63], a[4:7], v[108:111], v[48:63]
    ds_read_b64_tr_b16 v[100:101], v15 offset:4096
    ds_read_b64_tr_b16 v[102:103], v15 offset:4608
    s_waitcnt lgkmcnt(2)
    v_mfma_f32_32x32x16_bf16 v[32:47], a[8:11], v[96:99], v[32:47]
    ds_read_b64_tr_b16 v[104:105], v14 offset:6144
    ds_read_b64_tr_b16 v[106:107], v14 offset:6656
    s_add_u32 m0, s60, 36864
    s_mul_i32 s59, s49, 33792
    buffer_load_dwordx4 v3, s[16:19], s59 offen lds
    s_add_u32 s49, s49, 4
    s_and_b32 s49, s49, 63
    v_mfma_f32_32x32x16_bf16 v[200:215], v[96:99], v[96:99], v[200:215]
    s_waitcnt lgkmcnt(2)
    buffer_load_dwordx4 a[72:75], v4, s[20:23], s61 offen offset:2048
    v_mfma_f32_32x32x16_bf16 v[48:63], a[8:11], v[100:103], v[48:63]
    ds_read_b64_tr_b16 v[108:109], v15 offset:6144
    ds_read_b64_tr_b16 v[110:111], v15 offset:6656
    s_waitcnt lgkmcnt(2)
    v_mfma_f32_32x32x16_bf16 v[32:47], a[12:15], v[104:107], v[32:47]
    ds_read_b64_tr_b16 v[96:97], v14 offset:8192
    ds_read_b64_tr_b16 v[98:99], v14 offset:8704
    buffer_load_dwordx4 a[76:79], v4, s[20:23], s61 offen offset:3072
    v_mfma_f32_32x32x16_bf16 v[200:215], v[104:107], v[104:107], v[200:215]
    s_waitcnt lgkmcnt(2)
    v_mfma_f32_32x32x16_bf16 v[48:63], a[12:15], v[108:111], v[48:63]
    ds_read_b64_tr_b16 v[100:101], v15 offset:8192
    ds_read_b64_tr_b16 v[102:103], v15 offset:8704
    s_waitcnt lgkmcnt(2)
    v_mfma_f32_32x32x16_bf16 v[32:47], a[16:19], v[96:99], v[32:47]
    ds_read_b64_tr_b16 v[104:105], v14 offset:10240
    ds_read_b64_tr_b16 v[106:107], v14 offset:10752
    s_add_u32 m0, s60, 40960
    s_mul_i32 s59, s49, 33792
    buffer_load_dwordx4 v3, s[16:19], s59 offen lds
    s_add_u32 s49, s49, 4
    s_and_b32 s49, s49, 63
    v_mfma_f32_32x32x16_bf16 v[200:215], v[96:99], v[96:99], v[200:215]
    s_waitcnt lgkmcnt(2)
    s_add_u32 s61, s48, 5
    s_and_b32 s61, s61, 7
    s_lshl_b32 s61, s61, 12
    buffer_load_dwordx4 a[80:83], v4, s[20:23], s61 offen offset:0
    v_mfma_f32_32x32x16_bf16 v[48:63], a[16:19], v[100:103], v[48:63]
    ds_read_b64_tr_b16 v[108:109], v15 offset:10240
    ds_read_b64_tr_b16 v[110:111], v15 offset:10752
    s_waitcnt lgkmcnt(2)
    v_mfma_f32_32x32x16_bf16 v[32:47], a[20:23], v[104:107], v[32:47]
    ds_read_b64_tr_b16 v[96:97], v14 offset:12288
    ds_read_b64_tr_b16 v[98:99], v14 offset:12800
    buffer_load_dwordx4 a[84:87], v4, s[20:23], s61 offen offset:1024
    v_mfma_f32_32x32x16_bf16 v[200:215], v[104:107], v[104:107], v[200:215]
    s_waitcnt lgkmcnt(2)
    v_mfma_f32_32x32x16_bf16 v[48:63], a[20:23], v[108:111], v[48:63]
    ds_read_b64_tr_b16 v[100:101], v15 offset:12288
    ds_read_b64_tr_b16 v[102:103], v15 offset:12800
    s_waitcnt lgkmcnt(2)
    v_mfma_f32_32x32x16_bf16 v[32:47], a[24:27], v[96:99], v[32:47]
    ds_read_b64_tr_b16 v[104:105], v14 offset:14336
    ds_read_b64_tr_b16 v[106:107], v14 offset:14848
    s_add_u32 m0, s60, 45056
    s_mul_i32 s59, s49, 33792
    buffer_load_dwordx4 v3, s[16:19], s59 offen lds
    s_add_u32 s49, s49, 4
    s_and_b32 s49, s49, 63
    v_mfma_f32_32x32x16_bf16 v[200:215], v[96:99], v[96:99], v[200:215]
    s_waitcnt lgkmcnt(2)
    buffer_load_dwordx4 a[88:91], v4, s[20:23], s61 offen offset:2048
    v_mfma_f32_32x32x16_bf16 v[48:63], a[24:27], v[100:103], v[48:63]
    ds_read_b64_tr_b16 v[108:109], v15 offset:14336
    ds_read_b64_tr_b16 v[110:111], v15 offset:14848
    s_waitcnt vmcnt(11)
    s_barrier
    s_waitcnt lgkmcnt(2)
    v_mfma_f32_32x32x16_bf16 v[32:47], a[28:31], v[104:107], v[32:47]
    ds_read_b64_tr_b16 v[96:97], v14 offset:16384
    ds_read_b64_tr_b16 v[98:99], v14 offset:16896
    buffer_load_dwordx4 a[92:95], v4, s[20:23], s61 offen offset:3072
    v_mfma_f32_32x32x16_bf16 v[200:215], v[104:107], v[104:107], v[200:215]
    s_waitcnt lgkmcnt(2)
    v_mfma_f32_32x32x16_bf16 v[48:63], a[28:31], v[108:111], v[48:63]
    ds_read_b64_tr_b16 v[100:101], v15 offset:16384
    ds_read_b64_tr_b16 v[102:103], v15 offset:16896
    s_waitcnt lgkmcnt(2)
    v_mfma_f32_32x32x16_bf16 v[32:47], a[32:35], v[96:99], v[32:47]
    ds_read_b64_tr_b16 v[104:105], v14 offset:18432
    ds_read_b64_tr_b16 v[106:107], v14 offset:18944
    s_add_u32 m0, s60, 49152
    s_mul_i32 s59, s49, 33792
    buffer_load_dwordx4 v3, s[16:19], s59 offen lds
    s_add_u32 s49, s49, 4
    s_and_b32 s49, s49, 63
    v_mfma_f32_32x32x16_bf16 v[200:215], v[96:99], v[96:99], v[200:215]
    s_waitcnt lgkmcnt(2)
    s_add_u32 s61, s48, 6
    s_and_b32 s61, s61, 7
    s_lshl_b32 s61, s61, 12
    buffer_load_dwordx4 a[96:99], v4, s[20:23], s61 offen offset:0
    v_mfma_f32_32x32x16_bf16 v[48:63], a[32:35], v[100:103], v[48:63]
    ds_read_b64_tr_b16 v[108:109], v15 offset:18432
    ds_read_b64_tr_b16 v[110:111], v15 offset:18944
    s_waitcnt lgkmcnt(2)
    v_mfma_f32_32x32x16_bf16 v[32:47], a[36:39], v[104:107], v[32:47]
    ds_read_b64_tr_b16 v[96:97], v14 offset:20480
    ds_read_b64_tr_b16 v[98:99], v14 offset:20992
    buffer_load_dwordx4 a[100:103], v4, s[20:23], s61 offen offset:1024
    v_mfma_f32_32x32x16_bf16 v[200:215], v[104:107], v[104:107], v[200:215]
    s_waitcnt lgkmcnt(2)
    v_mfma_f32_32x32x16_bf16 v[48:63], a[36:39], v[108:111], v[48:63]
    ds_read_b64_tr_b16 v[100:101], v15 offset:20480
    ds_read_b64_tr_b16 v[102:103], v15 offset:20992
    s_waitcnt lgkmcnt(2)
    v_mfma_f32_32x32x16_bf16 v[32:47], a[40:43], v[96:99], v[32:47]
    ds_read_b64_tr_b16 v[104:105], v14 offset:22528
    ds_read_b64_tr_b16 v[106:107], v14 offset:23040
    s_add_u32 m0, s60, 53248
    s_mul_i32 s59, s49, 33792
    buffer_load_dwordx4 v3, s[16:19], s59 offen lds
    s_add_u32 s49, s49, 4
    s_and_b32 s49, s49, 63
    v_mfma_f32_32x32x16_bf16 v[200:215], v[96:99], v[96:99], v[200:215]
    s_waitcnt lgkmcnt(2)
    buffer_load_dwordx4 a[104:107], v4, s[20:23], s61 offen offset:2048
    v_mfma_f32_32x32x16_bf16 v[48:63], a[40:43], v[100:103], v[48:63]
    ds_read_b64_tr_b16 v[108:109], v15 offset:22528
    ds_read_b64_tr_b16 v[110:111], v15 offset:23040
    s_waitcnt lgkmcnt(2)
    v_mfma_f32_32x32x16_bf16 v[32:47], a[44:47], v[104:107], v[32:47]
    ds_read_b64_tr_b16 v[96:97], v14 offset:24576
    ds_read_b64_tr_b16 v[98:99], v14 offset:25088
    buffer_load_dwordx4 a[108:111], v4, s[20:23], s61 offen offset:3072
    v_mfma_f32_32x32x16_bf16 v[200:215], v[104:107], v[104:107], v[200:215]
    s_waitcnt lgkmcnt(2)
    v_mfma_f32_32x32x16_bf16 v[48:63], a[44:47], v[108:111], v[48:63]
    ds_read_b64_tr_b16 v[100:101], v15 offset:24576
    ds_read_b64_tr_b16 v[102:103], v15 offset:25088
    s_waitcnt lgkmcnt(2)
    v_mfma_f32_32x32x16_bf16 v[32:47], a[48:51], v[96:99], v[32:47]
    ds_read_b64_tr_b16 v[104:105], v14 offset:26624
    ds_read_b64_tr_b16 v[106:107], v14 offset:27136
    s_add_u32 m0, s60, 57344
    s_mul_i32 s59, s49, 33792
    buffer_load_dwordx4 v3, s[16:19], s59 offen lds
    s_add_u32 s49, s49, 4
    s_and_b32 s49, s49, 63
    v_mfma_f32_32x32x16_bf16 v[200:215], v[96:99], v[96:99], v[200:215]
    s_waitcnt lgkmcnt(2)
    s_add_u32 s61, s48, 7
    s_and_b32 s61, s61, 7
    s_lshl_b32 s61, s61, 12
    buffer_load_dwordx4 a[112:115], v4, s[20:23], s61 offen offset:0
    v_mfma_f32_32x32x16_bf16 v[48:63], a[48:51], v[100:103], v[48:63]
    ds_read_b64_tr_b16 v[108:109], v15 offset:26624
    ds_read_b64_tr_b16 v[110:111], v15 offset:27136
    s_waitcnt lgkmcnt(2)
    v_mfma_f32_32x32x16_bf16 v[32:47], a[52:55], v[104:107], v[32:47]
    ds_read_b64_tr_b16 v[96:97], v14 offset:28672
    ds_read_b64_tr_b16 v[98:99], v14 offset:29184
    buffer_load_dwordx4 a[116:119], v4, s[20:23], s61 offen offset:1024
    v_mfma_f32_32x32x16_bf16 v[200:215], v[104:107], v[104:107], v[200:215]
    s_waitcnt lgkmcnt(2)
    v_mfma_f32_32x32x16_bf16 v[48:63], a[52:55], v[108:111], v[48:63]
    ds_read_b64_tr_b16 v[100:101], v15 offset:28672
    ds_read_b64_tr_b16 v[102:103], v15 offset:29184
    s_waitcnt lgkmcnt(2)
    v_mfma_f32_32x32x16_bf16 v[32:47], a[56:59], v[96:99], v[32:47]
    ds_read_b64_tr_b16 v[104:105], v14 offset:30720
    ds_read_b64_tr_b16 v[106:107], v14 offset:31232
    s_add_u32 m0, s60, 61440
    s_mul_i32 s59, s49, 33792
    buffer_load_dwordx4 v3, s[16:19], s59 offen lds
    s_add_u32 s49, s49, 4
    s_and_b32 s49, s49, 63
    v_mfma_f32_32x32x16_bf16 v[200:215], v[96:99], v[96:99], v[200:215]
    s_waitcnt lgkmcnt(2)
    buffer_load_dwordx4 a[120:123], v4, s[20:23], s61 offen offset:2048
    v_mfma_f32_32x32x16_bf16 v[48:63], a[56:59], v[100:103], v[48:63]
    ds_read_b64_tr_b16 v[108:109], v15 offset:30720
    ds_read_b64_tr_b16 v[110:111], v15 offset:31232
    s_waitcnt vmcnt(11)
    s_barrier
    s_waitcnt lgkmcnt(2)
    v_mfma_f32_32x32x16_bf16 v[32:47], a[60:63], v[104:107], v[32:47]
    ds_read_b64_tr_b16 v[96:97], v14 offset:32768
    ds_read_b64_tr_b16 v[98:99], v14 offset:33280
    buffer_load_dwordx4 a[124:127], v4, s[20:23], s61 offen offset:3072
    v_mfma_f32_32x32x16_bf16 v[200:215], v[104:107], v[104:107], v[200:215]
    s_waitcnt lgkmcnt(2)
    v_mfma_f32_32x32x16_bf16 v[48:63], a[60:63], v[108:111], v[48:63]
    ds_read_b64_tr_b16 v[100:101], v15 offset:32768
    ds_read_b64_tr_b16 v[102:103], v15 offset:33280
    s_waitcnt lgkmcnt(2)
    v_mfma_f32_32x32x16_bf16 v[32:47], a[64:67], v[96:99], v[32:47]
    ds_read_b64_tr_b16 v[104:105], v14 offset:34816
    ds_read_b64_tr_b16 v[106:107], v14 offset:35328
    s_mov_b32 s63, 0
    buffer_load_dword v184, v8, s[28:31], s63 offen
    v_mfma_f32_32x32x16_bf16 v[200:215], v[96:99], v[96:99], v[200:215]
    s_waitcnt lgkmcnt(2)
    buffer_load_dword v188, v7, s[28:31], s63 offen
    v_mfma_f32_32x32x16_bf16 v[48:63], a[64:67], v[100:103], v[48:63]
    ds_read_b64_tr_b16 v[108:109], v15 offset:34816
    ds_read_b64_tr_b16 v[110:111], v15 offset:35328
    s_waitcnt lgkmcnt(2)
    v_mfma_f32_32x32x16_bf16 v[32:47], a[68:71], v[104:107], v[32:47]
    ds_read_b64_tr_b16 v[96:97], v14 offset:36864
    ds_read_b64_tr_b16 v[98:99], v14 offset:37376
    s_mov_b32 s63, 7168
    buffer_load_dword v185, v8, s[28:31], s63 offen
    v_mfma_f32_32x32x16_bf16 v[200:215], v[104:107], v[104:107], v[200:215]
    s_waitcnt lgkmcnt(2)
    v_mfma_f32_32x32x16_bf16 v[48:63], a[68:71], v[108:111], v[48:63]
    ds_read_b64_tr_b16 v[100:101], v15 offset:36864
    ds_read_b64_tr_b16 v[102:103], v15 offset:37376
    s_waitcnt lgkmcnt(2)
    v_mfma_f32_32x32x16_bf16 v[32:47], a[72:75], v[96:99], v[32:47]
    ds_read_b64_tr_b16 v[104:105], v14 offset:38912
    ds_read_b64_tr_b16 v[106:107], v14 offset:39424
    buffer_load_dword v189, v7, s[28:31], s63 offen
    v_mfma_f32_32x32x16_bf16 v[200:215], v[96:99], v[96:99], v[200:215]
    s_waitcnt lgkmcnt(2)
    s_mov_b32 s63, 14336
    buffer_load_dword v186, v8, s[28:31], s63 offen
    v_mfma_f32_32x32x16_bf16 v[48:63], a[72:75], v[100:103], v[48:63]
    ds_read_b64_tr_b16 v[108:109], v15 offset:38912
    ds_read_b64_tr_b16 v[110:111], v15 offset:39424
    s_waitcnt lgkmcnt(2)
    v_mfma_f32_32x32x16_bf16 v[32:47], a[76:79], v[104:107], v[32:47]
    ds_read_b64_tr_b16 v[96:97], v14 offset:40960
    ds_read_b64_tr_b16 v[98:99], v14 offset:41472
    buffer_load_dword v190, v7, s[28:31], s63 offen
    v_mfma_f32_32x32x16_bf16 v[200:215], v[104:107], v[104:107], v[200:215]
    s_waitcnt lgkmcnt(2)
    v_mfma_f32_32x32x16_bf16 v[48:63], a[76:79], v[108:111], v[48:63]
    ds_read_b64_tr_b16 v[100:101], v15 offset:40960
    ds_read_b64_tr_b16 v[102:103], v15 offset:41472
    s_waitcnt lgkmcnt(2)
    v_mfma_f32_32x32x16_bf16 v[32:47], a[80:83], v[96:99], v[32:47]
    ds_read_b64_tr_b16 v[104:105], v14 offset:43008
    ds_read_b64_tr_b16 v[106:107], v14 offset:43520
    s_mov_b32 s63, 21504
    buffer_load_dword v187, v8, s[28:31], s63 offen
    v_mfma_f32_32x32x16_bf16 v[200:215], v[96:99], v[96:99], v[200:215]
    s_waitcnt lgkmcnt(2)
    buffer_load_dword v191, v7, s[28:31], s63 offen
    v_mfma_f32_32x32x16_bf16 v[48:63], a[80:83], v[100:103], v[48:63]
    ds_read_b64_tr_b16 v[108:109], v15 offset:43008
    ds_read_b64_tr_b16 v[110:111], v15 offset:43520
    s_waitcnt lgkmcnt(2)
    v_mfma_f32_32x32x16_bf16 v[32:47], a[84:87], v[104:107], v[32:47]
    ds_read_b64_tr_b16 v[96:97], v14 offset:45056
    ds_read_b64_tr_b16 v[98:99], v14 offset:45568
    s_add_u32 s62, s48, 0
    s_and_b32 s62, s62, 7
    s_lshl_b32 s62, s62, 12
    buffer_load_dwordx4 a[128:131], v4, s[24:27], s62 offen offset:0
    v_mfma_f32_32x32x16_bf16 v[200:215], v[104:107], v[104:107], v[200:215]
    s_waitcnt lgkmcnt(2)
    v_mfma_f32_32x32x16_bf16 v[48:63], a[84:87], v[108:111], v[48:63]
    ds_read_b64_tr_b16 v[100:101], v15 offset:45056
    ds_read_b64_tr_b16 v[102:103], v15 offset:45568
    s_waitcnt lgkmcnt(2)
    v_mfma_f32_32x32x16_bf16 v[32:47], a[88:91], v[96:99], v[32:47]
    ds_read_b64_tr_b16 v[104:105], v14 offset:47104
    ds_read_b64_tr_b16 v[106:107], v14 offset:47616
    buffer_load_dwordx4 a[132:135], v4, s[24:27], s62 offen offset:1024
    v_mfma_f32_32x32x16_bf16 v[200:215], v[96:99], v[96:99], v[200:215]
    s_waitcnt lgkmcnt(2)
    buffer_load_dwordx4 a[136:139], v4, s[24:27], s62 offen offset:2048
    v_mfma_f32_32x32x16_bf16 v[48:63], a[88:91], v[100:103], v[48:63]
    ds_read_b64_tr_b16 v[108:109], v15 offset:47104
    ds_read_b64_tr_b16 v[110:111], v15 offset:47616
    s_waitcnt vmcnt(11)
    s_barrier
    s_waitcnt lgkmcnt(2)
    v_mfma_f32_32x32x16_bf16 v[32:47], a[92:95], v[104:107], v[32:47]
    ds_read_b64_tr_b16 v[96:97], v14 offset:49152
    ds_read_b64_tr_b16 v[98:99], v14 offset:49664
    buffer_load_dwordx4 a[140:143], v4, s[24:27], s62 offen offset:3072
    v_mfma_f32_32x32x16_bf16 v[200:215], v[104:107], v[104:107], v[200:215]
    s_waitcnt lgkmcnt(2)
    v_mfma_f32_32x32x16_bf16 v[48:63], a[92:95], v[108:111], v[48:63]
    ds_read_b64_tr_b16 v[100:101], v15 offset:49152
    ds_read_b64_tr_b16 v[102:103], v15 offset:49664
    s_waitcnt lgkmcnt(2)
    v_mfma_f32_32x32x16_bf16 v[32:47], a[96:99], v[96:99], v[32:47]
    ds_read_b64_tr_b16 v[104:105], v14 offset:51200
    ds_read_b64_tr_b16 v[106:107], v14 offset:51712
    s_add_u32 s62, s48, 1
    s_and_b32 s62, s62, 7
    s_lshl_b32 s62, s62, 12
    buffer_load_dwordx4 a[144:147], v4, s[24:27], s62 offen offset:0
    v_mfma_f32_32x32x16_bf16 v[200:215], v[96:99], v[96:99], v[200:215]
    s_waitcnt lgkmcnt(2)
    buffer_load_dwordx4 a[148:151], v4, s[24:27], s62 offen offset:1024
    v_mfma_f32_32x32x16_bf16 v[48:63], a[96:99], v[100:103], v[48:63]
    ds_read_b64_tr_b16 v[108:109], v15 offset:51200
    ds_read_b64_tr_b16 v[110:111], v15 offset:51712
    s_waitcnt lgkmcnt(2)
    v_mfma_f32_32x32x16_bf16 v[32:47], a[100:103], v[104:107], v[32:47]
    ds_read_b64_tr_b16 v[96:97], v14 offset:53248
    ds_read_b64_tr_b16 v[98:99], v14 offset:53760
    buffer_load_dwordx4 a[152:155], v4, s[24:27], s62 offen offset:2048
    v_mfma_f32_32x32x16_bf16 v[200:215], v[104:107], v[104:107], v[200:215]
    s_waitcnt lgkmcnt(2)
    v_mfma_f32_32x32x16_bf16 v[48:63], a[100:103], v[108:111], v[48:63]
    ds_read_b64_tr_b16 v[100:101], v15 offset:53248
    ds_read_b64_tr_b16 v[102:103], v15 offset:53760
    s_waitcnt lgkmcnt(2)
    v_mfma_f32_32x32x16_bf16 v[32:47], a[104:107], v[96:99], v[32:47]
    ds_read_b64_tr_b16 v[104:105], v14 offset:55296
    ds_read_b64_tr_b16 v[106:107], v14 offset:55808
    buffer_load_dwordx4 a[156:159], v4, s[24:27], s62 offen offset:3072
    v_mfma_f32_32x32x16_bf16 v[200:215], v[96:99], v[96:99], v[200:215]
    s_waitcnt lgkmcnt(2)
    s_add_u32 s62, s48, 2
    s_and_b32 s62, s62, 7
    s_lshl_b32 s62, s62, 12
    buffer_load_dwordx4 a[160:163], v4, s[24:27], s62 offen offset:0
    v_mfma_f32_32x32x16_bf16 v[48:63], a[104:107], v[100:103], v[48:63]
    ds_read_b64_tr_b16 v[108:109], v15 offset:55296
    ds_read_b64_tr_b16 v[110:111], v15 offset:55808
    s_waitcnt lgkmcnt(2)
    v_mfma_f32_32x32x16_bf16 v[32:47], a[108:111], v[104:107], v[32:47]
    ds_read_b64_tr_b16 v[96:97], v14 offset:57344
    ds_read_b64_tr_b16 v[98:99], v14 offset:57856
    buffer_load_dwordx4 a[164:167], v4, s[24:27], s62 offen offset:1024
    v_mfma_f32_32x32x16_bf16 v[200:215], v[104:107], v[104:107], v[200:215]
    s_waitcnt lgkmcnt(2)
    v_mfma_f32_32x32x16_bf16 v[48:63], a[108:111], v[108:111], v[48:63]
    ds_read_b64_tr_b16 v[100:101], v15 offset:57344
    ds_read_b64_tr_b16 v[102:103], v15 offset:57856
    s_waitcnt lgkmcnt(2)
    v_mfma_f32_32x32x16_bf16 v[32:47], a[112:115], v[96:99], v[32:47]
    ds_read_b64_tr_b16 v[104:105], v14 offset:59392
    ds_read_b64_tr_b16 v[106:107], v14 offset:59904
    buffer_load_dwordx4 a[168:171], v4, s[24:27], s62 offen offset:2048
    v_mfma_f32_32x32x16_bf16 v[200:215], v[96:99], v[96:99], v[200:215]
    s_waitcnt lgkmcnt(2)
    buffer_load_dwordx4 a[172:175], v4, s[24:27], s62 offen offset:3072
    v_mfma_f32_32x32x16_bf16 v[48:63], a[112:115], v[100:103], v[48:63]
    ds_read_b64_tr_b16 v[108:109], v15 offset:59392
    ds_read_b64_tr_b16 v[110:111], v15 offset:59904
    s_waitcnt lgkmcnt(2)
    v_mfma_f32_32x32x16_bf16 v[32:47], a[116:119], v[104:107], v[32:47]
    ds_read_b64_tr_b16 v[96:97], v14 offset:61440
    ds_read_b64_tr_b16 v[98:99], v14 offset:61952
    s_add_u32 s62, s48, 3
    s_and_b32 s62, s62, 7
    s_lshl_b32 s62, s62, 12
    buffer_load_dwordx4 a[176:179], v4, s[24:27], s62 offen offset:0
    v_mfma_f32_32x32x16_bf16 v[200:215], v[104:107], v[104:107], v[200:215]
    s_waitcnt lgkmcnt(2)
    v_mfma_f32_32x32x16_bf16 v[48:63], a[116:119], v[108:111], v[48:63]
    ds_read_b64_tr_b16 v[100:101], v15 offset:61440
    ds_read_b64_tr_b16 v[102:103], v15 offset:61952
    s_waitcnt lgkmcnt(2)
    v_mfma_f32_32x32x16_bf16 v[32:47], a[120:123], v[96:99], v[32:47]
    ds_read_b64_tr_b16 v[104:105], v14 offset:63488
    ds_read_b64_tr_b16 v[106:107], v14 offset:64000
    buffer_load_dwordx4 a[180:183], v4, s[24:27], s62 offen offset:1024
    v_mfma_f32_32x32x16_bf16 v[200:215], v[96:99], v[96:99], v[200:215]
    s_waitcnt lgkmcnt(2)
    buffer_load_dwordx4 a[184:187], v4, s[24:27], s62 offen offset:2048
    v_mfma_f32_32x32x16_bf16 v[48:63], a[120:123], v[100:103], v[48:63]
    ds_read_b64_tr_b16 v[108:109], v15 offset:63488
    ds_read_b64_tr_b16 v[110:111], v15 offset:64000
    s_waitcnt lgkmcnt(2)
    v_mfma_f32_32x32x16_bf16 v[32:47], a[124:127], v[104:107], v[32:47]
    buffer_load_dwordx4 a[188:191], v4, s[24:27], s62 offen offset:3072
    v_mfma_f32_32x32x16_bf16 v[200:215], v[104:107], v[104:107], v[200:215]
    s_waitcnt lgkmcnt(0)
    v_mfma_f32_32x32x16_bf16 v[48:63], a[124:127], v[108:111], v[48:63]
    v_cmp_ne_u32 vcc, 0, v112
    v_cmp_ne_u32 s[78:79], 0, v113
    s_nop 9
    v_cndmask_b32 v152, v200, v201, vcc
    v_cndmask_b32 v153, v202, v203, vcc
    v_cndmask_b32 v154, v204, v205, vcc
    v_cndmask_b32 v155, v206, v207, vcc
    v_cndmask_b32 v156, v208, v209, vcc
    v_cndmask_b32 v157, v210, v211, vcc
    v_cndmask_b32 v158, v212, v213, vcc
    v_cndmask_b32 v159, v214, v215, vcc
    v_cmp_ne_u32 vcc, 0, v114
    v_cndmask_b32 v160, v152, v153, s[78:79]
    v_cndmask_b32 v161, v154, v155, s[78:79]
    v_cndmask_b32 v162, v156, v157, s[78:79]
    v_cndmask_b32 v163, v158, v159, s[78:79]
    v_cmp_ne_u32 s[78:79], 0, v115
    v_cndmask_b32 v164, v160, v161, vcc
    v_cndmask_b32 v165, v162, v163, vcc
    v_cndmask_b32 v17, v164, v165, s[78:79]
KB_P1J:
    ds_write_b32 v251, v17
    s_waitcnt vmcnt(16)
    v_add_f32 v184, v184, v185
    v_add_f32 v186, v186, v187
    v_add_f32 v188, v188, v189
    v_add_f32 v190, v190, v191
    v_add_f32 v184, v184, v186
    v_add_f32 v188, v188, v190
    s_nop 1
    v_permlane32_swap_b32 v184, v188
    s_nop 1
    v_add_f32 v184, v184, v188
    ds_write_b32 v253, v184
    s_waitcnt lgkmcnt(0)
    s_barrier
    v_xor_b32 v21, 128, v252
    ds_read_b32 v16, v252
    ds_read_b32 v17, v252 offset:256
    ds_read_b32 v184, v21
    ds_read_b32 v185, v21 offset:256
    ds_read_b128 v[120:123], v254 offset:0
    ds_read_b128 v[124:127], v254 offset:32
    ds_read_b128 v[128:131], v254 offset:64
    ds_read_b128 v[132:135], v254 offset:96
    ds_read_b128 v[136:139], v254 offset:128
    ds_read_b128 v[140:143], v254 offset:160
    ds_read_b128 v[144:147], v254 offset:192
    ds_read_b128 v[148:151], v254 offset:224
    s_waitcnt lgkmcnt(8)
    v_mul_f32 v16, s65, v16
    v_mul_f32 v17, s65, v17
    v_fma_f32 v17, -v16, v16, v17
    v_max_f32 v17, 0, v17
    v_add_f32 v17, s66, v17
    v_rsq_f32 v18, v17
    s_nop 0
    v_mul_f32 v19, v16, v18
    v_sub_f32 v19, 0, v19
    v_mul_f32 v184, s65, v184
    v_mul_f32 v185, s65, v185
    v_fma_f32 v185, -v184, v184, v185
    v_max_f32 v185, 0, v185
    v_add_f32 v185, s66, v185
    v_rsq_f32 v24, v185
    s_nop 0
    v_mul_f32 v25, v184, v24
    v_sub_f32 v25, 0, v25
    s_waitcnt lgkmcnt(0)
    v_pk_mul_f32 v[32:33], v[32:33], v[18:19] op_sel_hi:[1,0]
    v_pk_mul_f32 v[34:35], v[34:35], v[18:19] op_sel_hi:[1,0]
    v_pk_mul_f32 v[36:37], v[36:37], v[18:19] op_sel_hi:[1,0]
    v_pk_mul_f32 v[38:39], v[38:39], v[18:19] op_sel_hi:[1,0]
    v_pk_mul_f32 v[40:41], v[40:41], v[18:19] op_sel_hi:[1,0]
    v_pk_mul_f32 v[42:43], v[42:43], v[18:19] op_sel_hi:[1,0]
    v_pk_mul_f32 v[44:45], v[44:45], v[18:19] op_sel_hi:[1,0]
    v_pk_mul_f32 v[46:47], v[46:47], v[18:19] op_sel_hi:[1,0]
    v_pk_fma_f32 v[32:33], v[120:121], v[18:19], v[32:33] op_sel:[0,1,0] op_sel_hi:[1,1,1]
    v_pk_fma_f32 v[34:35], v[122:123], v[18:19], v[34:35] op_sel:[0,1,0] op_sel_hi:[1,1,1]
    v_pk_fma_f32 v[36:37], v[124:125], v[18:19], v[36:37] op_sel:[0,1,0] op_sel_hi:[1,1,1]
    v_pk_fma_f32 v[38:39], v[126:127], v[18:19], v[38:39] op_sel:[0,1,0] op_sel_hi:[1,1,1]
    s_add_u32 s62, s48, 4
    s_and_b32 s62, s62, 7
    s_lshl_b32 s62, s62, 12
    buffer_load_dwordx4 a[192:195], v4, s[24:27], s62 offen offset:0
    v_pk_fma_f32 v[40:41], v[128:129], v[18:19], v[40:41] op_sel:[0,1,0] op_sel_hi:[1,1,1]
    v_pk_fma_f32 v[42:43], v[130:131], v[18:19], v[42:43] op_sel:[0,1,0] op_sel_hi:[1,1,1]
    v_pk_fma_f32 v[44:45], v[132:133], v[18:19], v[44:45] op_sel:[0,1,0] op_sel_hi:[1,1,1]
    v_pk_fma_f32 v[46:47], v[134:135], v[18:19], v[46:47] op_sel:[0,1,0] op_sel_hi:[1,1,1]
    v_pk_mul_f32 v[48:49], v[48:49], v[24:25] op_sel_hi:[1,0]
    v_pk_mul_f32 v[50:51], v[50:51], v[24:25] op_sel_hi:[1,0]
    v_pk_mul_f32 v[52:53], v[52:53], v[24:25] op_sel_hi:[1,0]
    v_pk_mul_f32 v[54:55], v[54:55], v[24:25] op_sel_hi:[1,0]
    v_pk_mul_f32 v[56:57], v[56:57], v[24:25] op_sel_hi:[1,0]
    v_pk_mul_f32 v[58:59], v[58:59], v[24:25] op_sel_hi:[1,0]
    v_pk_mul_f32 v[60:61], v[60:61], v[24:25] op_sel_hi:[1,0]
    v_pk_mul_f32 v[62:63], v[62:63], v[24:25] op_sel_hi:[1,0]
    buffer_load_dwordx4 a[196:199], v4, s[24:27], s62 offen offset:1024
    v_pk_fma_f32 v[48:49], v[120:121], v[24:25], v[48:49] op_sel:[0,1,0] op_sel_hi:[1,1,1]
    v_pk_fma_f32 v[50:51], v[122:123], v[24:25], v[50:51] op_sel:[0,1,0] op_sel_hi:[1,1,1]
    v_pk_fma_f32 v[52:53], v[124:125], v[24:25], v[52:53] op_sel:[0,1,0] op_sel_hi:[1,1,1]
    v_pk_fma_f32 v[54:55], v[126:127], v[24:25], v[54:55] op_sel:[0,1,0] op_sel_hi:[1,1,1]
    v_pk_fma_f32 v[56:57], v[128:129], v[24:25], v[56:57] op_sel:[0,1,0] op_sel_hi:[1,1,1]
    v_pk_fma_f32 v[58:59], v[130:131], v[24:25], v[58:59] op_sel:[0,1,0] op_sel_hi:[1,1,1]
    v_pk_fma_f32 v[60:61], v[132:133], v[24:25], v[60:61] op_sel:[0,1,0] op_sel_hi:[1,1,1]
    v_pk_fma_f32 v[62:63], v[134:135], v[24:25], v[62:63] op_sel:[0,1,0] op_sel_hi:[1,1,1]
    v_pk_mul_f32 v[152:153], v[32:33], v[32:33]
    v_pk_mul_f32 v[154:155], v[34:35], v[34:35]
    v_pk_mul_f32 v[156:157], v[36:37], v[36:37]
    v_pk_mul_f32 v[158:159], v[38:39], v[38:39]
    buffer_load_dwordx4 a[200:203], v4, s[24:27], s62 offen offset:2048
    v_pk_mul_f32 v[160:161], v[40:41], v[40:41]
    v_pk_mul_f32 v[162:163], v[42:43], v[42:43]
    v_pk_mul_f32 v[164:165], v[44:45], v[44:45]
    v_pk_mul_f32 v[166:167], v[46:47], v[46:47]
    v_pk_mul_f32 v[168:169], v[48:49], v[48:49]
    v_pk_mul_f32 v[170:171], v[50:51], v[50:51]
    v_pk_mul_f32 v[172:173], v[52:53], v[52:53]
    v_pk_mul_f32 v[174:175], v[54:55], v[54:55]
    v_pk_mul_f32 v[176:177], v[56:57], v[56:57]
    v_pk_mul_f32 v[178:179], v[58:59], v[58:59]
    v_pk_mul_f32 v[180:181], v[60:61], v[60:61]
    v_pk_mul_f32 v[182:183], v[62:63], v[62:63]
    buffer_load_dwordx4 a[204:207], v4, s[24:27], s62 offen offset:3072
    v_pk_fma_f32 v[152:153], v[152:153], v[28:29], v[26:27]
    v_pk_fma_f32 v[154:155], v[154:155], v[28:29], v[26:27]
    v_pk_fma_f32 v[156:157], v[156:157], v[28:29], v[26:27]
    v_pk_fma_f32 v[158:159], v[158:159], v[28:29], v[26:27]
    v_pk_fma_f32 v[160:161], v[160:161], v[28:29], v[26:27]
    v_pk_fma_f32 v[162:163], v[162:163], v[28:29], v[26:27]
    v_pk_fma_f32 v[164:165], v[164:165], v[28:29], v[26:27]
    v_pk_fma_f32 v[166:167], v[166:167], v[28:29], v[26:27]
    v_pk_fma_f32 v[168:169], v[168:169], v[28:29], v[26:27]
    v_pk_fma_f32 v[170:171], v[170:171], v[28:29], v[26:27]
    v_pk_fma_f32 v[172:173], v[172:173], v[28:29], v[26:27]
    v_pk_fma_f32 v[174:175], v[174:175], v[28:29], v[26:27]
    s_add_u32 s62, s48, 5
    s_and_b32 s62, s62, 7
    s_lshl_b32 s62, s62, 12
    buffer_load_dwordx4 a[208:211], v4, s[24:27], s62 offen offset:0
    v_pk_fma_f32 v[176:177], v[176:177], v[28:29], v[26:27]
    v_pk_fma_f32 v[178:179], v[178:179], v[28:29], v[26:27]
    v_pk_fma_f32 v[180:181], v[180:181], v[28:29], v[26:27]
    v_pk_fma_f32 v[182:183], v[182:183], v[28:29], v[26:27]
    v_pk_mul_f32 v[152:153], v[152:153], v[32:33]
    v_pk_mul_f32 v[154:155], v[154:155], v[34:35]
    v_pk_mul_f32 v[156:157], v[156:157], v[36:37]
    v_pk_mul_f32 v[158:159], v[158:159], v[38:39]
    v_pk_mul_f32 v[160:161], v[160:161], v[40:41]
    v_pk_mul_f32 v[162:163], v[162:163], v[42:43]
    v_pk_mul_f32 v[164:165], v[164:165], v[44:45]
    v_pk_mul_f32 v[166:167], v[166:167], v[46:47]
    buffer_load_dwordx4 a[212:215], v4, s[24:27], s62 offen offset:1024
    v_pk_mul_f32 v[168:169], v[168:169], v[48:49]
    v_pk_mul_f32 v[170:171], v[170:171], v[50:51]
    v_pk_mul_f32 v[172:173], v[172:173], v[52:53]
    v_pk_mul_f32 v[174:175], v[174:175], v[54:55]
    v_pk_mul_f32 v[176:177], v[176:177], v[56:57]
    v_pk_mul_f32 v[178:179], v[178:179], v[58:59]
    v_pk_mul_f32 v[180:181], v[180:181], v[60:61]
    v_pk_mul_f32 v[182:183], v[182:183], v[62:63]
    v_exp_f32 v152, v152
    v_exp_f32 v153, v153
    v_exp_f32 v154, v154
    v_exp_f32 v155, v155
    buffer_load_dwordx4 a[216:219], v4, s[24:27], s62 offen offset:2048
    v_exp_f32 v156, v156
    v_exp_f32 v157, v157
    v_exp_f32 v158, v158
    v_exp_f32 v159, v159
    v_exp_f32 v160, v160
    v_exp_f32 v161, v161
    v_exp_f32 v162, v162
    v_exp_f32 v163, v163
    v_exp_f32 v164, v164
    v_exp_f32 v165, v165
    v_exp_f32 v166, v166
    v_exp_f32 v167, v167
    buffer_load_dwordx4 a[220:223], v4, s[24:27], s62 offen offset:3072
    v_exp_f32 v168, v168
    v_exp_f32 v169, v169
    v_exp_f32 v170, v170
    v_exp_f32 v171, v171
    v_exp_f32 v172, v172
    v_exp_f32 v173, v173
    v_exp_f32 v174, v174
    v_exp_f32 v175, v175
    v_exp_f32 v176, v176
    v_exp_f32 v177, v177
    v_exp_f32 v178, v178
    v_exp_f32 v179, v179
    s_add_u32 s62, s48, 6
    s_and_b32 s62, s62, 7
    s_lshl_b32 s62, s62, 12
    buffer_load_dwordx4 a[224:227], v4, s[24:27], s62 offen offset:0
    v_exp_f32 v180, v180
    v_exp_f32 v181, v181
    v_exp_f32 v182, v182
    v_exp_f32 v183, v183
    v_pk_add_f32 v[152:153], v[152:153], v[30:31]
    v_pk_add_f32 v[154:155], v[154:155], v[30:31]
    v_pk_add_f32 v[156:157], v[156:157], v[30:31]
    v_pk_add_f32 v[158:159], v[158:159], v[30:31]
    v_pk_add_f32 v[160:161], v[160:161], v[30:31]
    v_pk_add_f32 v[162:163], v[162:163], v[30:31]
    v_pk_add_f32 v[164:165], v[164:165], v[30:31]
    v_pk_add_f32 v[166:167], v[166:167], v[30:31]
    buffer_load_dwordx4 a[228:231], v4, s[24:27], s62 offen offset:1024
    v_pk_add_f32 v[168:169], v[168:169], v[30:31]
    v_pk_add_f32 v[170:171], v[170:171], v[30:31]
    v_pk_add_f32 v[172:173], v[172:173], v[30:31]
    v_pk_add_f32 v[174:175], v[174:175], v[30:31]
    v_pk_add_f32 v[176:177], v[176:177], v[30:31]
    v_pk_add_f32 v[178:179], v[178:179], v[30:31]
    v_pk_add_f32 v[180:181], v[180:181], v[30:31]
    v_pk_add_f32 v[182:183], v[182:183], v[30:31]
    v_rcp_f32 v152, v152
    v_rcp_f32 v153, v153
    v_rcp_f32 v154, v154
    v_rcp_f32 v155, v155
    buffer_load_dwordx4 a[232:235], v4, s[24:27], s62 offen offset:2048
    v_rcp_f32 v156, v156
    v_rcp_f32 v157, v157
    v_rcp_f32 v158, v158
    v_rcp_f32 v159, v159
    v_rcp_f32 v160, v160
    v_rcp_f32 v161, v161
    v_rcp_f32 v162, v162
    v_rcp_f32 v163, v163
    v_rcp_f32 v164, v164
    v_rcp_f32 v165, v165
    v_rcp_f32 v166, v166
    v_rcp_f32 v167, v167
    buffer_load_dwordx4 a[236:239], v4, s[24:27], s62 offen offset:3072
    v_rcp_f32 v168, v168
    v_rcp_f32 v169, v169
    v_rcp_f32 v170, v170
    v_rcp_f32 v171, v171
    v_rcp_f32 v172, v172
    v_rcp_f32 v173, v173
    v_rcp_f32 v174, v174
    v_rcp_f32 v175, v175
    v_rcp_f32 v176, v176
    v_rcp_f32 v177, v177
    v_rcp_f32 v178, v178
    v_rcp_f32 v179, v179
    s_add_u32 s62, s48, 7
    s_and_b32 s62, s62, 7
    s_lshl_b32 s62, s62, 12
    buffer_load_dwordx4 a[240:243], v4, s[24:27], s62 offen offset:0
    v_rcp_f32 v180, v180
    v_rcp_f32 v181, v181
    v_rcp_f32 v182, v182
    v_rcp_f32 v183, v183
    v_pk_mul_f32 v[32:33], v[32:33], v[152:153]
    v_pk_mul_f32 v[34:35], v[34:35], v[154:155]
    v_pk_mul_f32 v[36:37], v[36:37], v[156:157]
    v_pk_mul_f32 v[38:39], v[38:39], v[158:159]
    v_pk_mul_f32 v[40:41], v[40:41], v[160:161]
    v_pk_mul_f32 v[42:43], v[42:43], v[162:163]
    v_pk_mul_f32 v[44:45], v[44:45], v[164:165]
    v_pk_mul_f32 v[46:47], v[46:47], v[166:167]
    buffer_load_dwordx4 a[244:247], v4, s[24:27], s62 offen offset:1024
    v_pk_mul_f32 v[48:49], v[48:49], v[168:169]
    v_pk_mul_f32 v[50:51], v[50:51], v[170:171]
    v_pk_mul_f32 v[52:53], v[52:53], v[172:173]
    v_pk_mul_f32 v[54:55], v[54:55], v[174:175]
    v_pk_mul_f32 v[56:57], v[56:57], v[176:177]
    v_pk_mul_f32 v[58:59], v[58:59], v[178:179]
    v_pk_mul_f32 v[60:61], v[60:61], v[180:181]
    v_pk_mul_f32 v[62:63], v[62:63], v[182:183]
    v_pk_add_f32 v[184:185], v[32:33], v[34:35]
    v_pk_mul_f32 v[186:187], v[32:33], v[32:33]
    v_pk_fma_f32 v[186:187], v[34:35], v[34:35], v[186:187]
    v_pk_add_f32 v[184:185], v[184:185], v[36:37]
    buffer_load_dwordx4 a[248:251], v4, s[24:27], s62 offen offset:2048
    v_pk_fma_f32 v[186:187], v[36:37], v[36:37], v[186:187]
    v_pk_add_f32 v[184:185], v[184:185], v[38:39]
    v_pk_fma_f32 v[186:187], v[38:39], v[38:39], v[186:187]
    v_pk_add_f32 v[184:185], v[184:185], v[40:41]
    v_pk_fma_f32 v[186:187], v[40:41], v[40:41], v[186:187]
    v_pk_add_f32 v[184:185], v[184:185], v[42:43]
    v_pk_fma_f32 v[186:187], v[42:43], v[42:43], v[186:187]
    v_pk_add_f32 v[184:185], v[184:185], v[44:45]
    v_pk_fma_f32 v[186:187], v[44:45], v[44:45], v[186:187]
    v_pk_add_f32 v[184:185], v[184:185], v[46:47]
    v_pk_fma_f32 v[186:187], v[46:47], v[46:47], v[186:187]
    v_pk_add_f32 v[188:189], v[48:49], v[50:51]
    buffer_load_dwordx4 a[252:255], v4, s[24:27], s62 offen offset:3072
    v_pk_mul_f32 v[190:191], v[48:49], v[48:49]
    v_pk_fma_f32 v[190:191], v[50:51], v[50:51], v[190:191]
    v_pk_add_f32 v[188:189], v[188:189], v[52:53]
    v_pk_fma_f32 v[190:191], v[52:53], v[52:53], v[190:191]
    v_pk_add_f32 v[188:189], v[188:189], v[54:55]
    v_pk_fma_f32 v[190:191], v[54:55], v[54:55], v[190:191]
    v_pk_add_f32 v[188:189], v[188:189], v[56:57]
    v_pk_fma_f32 v[190:191], v[56:57], v[56:57], v[190:191]
    v_pk_add_f32 v[188:189], v[188:189], v[58:59]
    v_pk_fma_f32 v[190:191], v[58:59], v[58:59], v[190:191]
    v_pk_add_f32 v[188:189], v[188:189], v[60:61]
    v_pk_fma_f32 v[190:191], v[60:61], v[60:61], v[190:191]
    v_pk_add_f32 v[188:189], v[188:189], v[62:63]
    v_pk_fma_f32 v[190:191], v[62:63], v[62:63], v[190:191]
    v_add_f32 v184, v184, v185
    v_add_f32 v185, v186, v187
    v_add_f32 v186, v188, v189
    v_add_f32 v187, v190, v191
    s_nop 1
    v_permlane32_swap_b32 v184, v186
    v_permlane32_swap_b32 v185, v187
    v_xor_b32 v188, s58, v6
    v_lshlrev_b32 v188, 8, v188
    s_lshl_b32 s69, s50, 9
    s_add_u32 s69, s69, 115200
    v_add_f32 v184, v184, v186
    v_add_f32 v185, v185, v187
    v_add3_u32 v188, v188, v22, s69
    ds_write_b64 v188, v[184:185]
    v_lshlrev_b32 v189, 3, v2
    s_waitcnt vmcnt(0) lgkmcnt(0)
    s_barrier
    s_cmp_eq_u32 s50, 0
    s_cbranch_scc0 KB_NOPUB
    v_add_u32 v189, 115200, v189
    ds_read_b64 v[176:177], v189 offset:0
    ds_read_b64 v[178:179], v189 offset:512
    ds_read_b64 v[180:181], v189 offset:1024
    ds_read_b64 v[182:183], v189 offset:1536
    s_lshl_b32 s69, s52, 9
    s_waitcnt lgkmcnt(0)
    v_add_f32 v176, v176, v178
    v_add_f32 v177, v177, v179
    v_add_f32 v180, v180, v182
    v_add_f32 v181, v181, v183
    v_add_f32 v176, v176, v180
    v_add_f32 v177, v177, v181
    v_min_u32 v177, 0xfffffffe, v177
    buffer_store_dwordx2 v[176:177], v250, s[32:35], s69 offen sc0 sc1
KB_NOPUB:
    ds_read_b64_tr_b16 v[96:97], v14 offset:0
    ds_read_b64_tr_b16 v[98:99], v14 offset:512
    ds_read_b64_tr_b16 v[100:101], v15 offset:0
    ds_read_b64_tr_b16 v[102:103], v15 offset:512
    s_waitcnt lgkmcnt(2)
    v_mfma_f32_32x32x16_bf16 v[64:79], a[128:131], v[96:99], 0
    s_add_u32 m0, s72, 0
    ds_read_b64_tr_b16 v[104:105], v14 offset:2048
    ds_read_b64_tr_b16 v[106:107], v14 offset:2560
    buffer_load_dwordx4 v234, s[44:47], s68 offen lds
    s_waitcnt lgkmcnt(2)
    v_mfma_f32_32x32x16_bf16 v[80:95], a[128:131], v[100:103], 0
    ds_read_b64_tr_b16 v[108:109], v15 offset:2048
    ds_read_b64_tr_b16 v[110:111], v15 offset:2560
    s_waitcnt lgkmcnt(2)
    v_mfma_f32_32x32x16_bf16 v[64:79], a[132:135], v[104:107], v[64:79]
    s_add_u32 m0, s72, 1024
    ds_read_b64_tr_b16 v[96:97], v14 offset:4096
    ds_read_b64_tr_b16 v[98:99], v14 offset:4608
    buffer_load_dwordx4 v235, s[44:47], s68 offen lds
    s_waitcnt lgkmcnt(2)
    v_mfma_f32_32x32x16_bf16 v[80:95], a[132:135], v[108:111], v[80:95]
    ds_read_b64_tr_b16 v[100:101], v15 offset:4096
    ds_read_b64_tr_b16 v[102:103], v15 offset:4608
    s_waitcnt lgkmcnt(2)
    v_mfma_f32_32x32x16_bf16 v[64:79], a[136:139], v[96:99], v[64:79]
    s_add_u32 m0, s72, 2048
    ds_read_b64_tr_b16 v[104:105], v14 offset:6144
    ds_read_b64_tr_b16 v[106:107], v14 offset:6656
    buffer_load_dwordx4 v116, s[44:47], s68 offen lds
    s_waitcnt lgkmcnt(2)
    v_mfma_f32_32x32x16_bf16 v[80:95], a[136:139], v[100:103], v[80:95]
    ds_read_b64_tr_b16 v[108:109], v15 offset:6144
    ds_read_b64_tr_b16 v[110:111], v15 offset:6656
    s_waitcnt lgkmcnt(2)
    v_mfma_f32_32x32x16_bf16 v[64:79], a[140:143], v[104:107], v[64:79]
    s_add_u32 m0, s72, 3072
    ds_read_b64_tr_b16 v[96:97], v14 offset:8192
    ds_read_b64_tr_b16 v[98:99], v14 offset:8704
    buffer_load_dwordx4 v117, s[44:47], s68 offen lds
    s_add_u32 s68, s68, 128
    s_waitcnt lgkmcnt(2)
    v_mfma_f32_32x32x16_bf16 v[80:95], a[140:143], v[108:111], v[80:95]
    ds_read_b64_tr_b16 v[100:101], v15 offset:8192
    ds_read_b64_tr_b16 v[102:103], v15 offset:8704
    s_waitcnt lgkmcnt(2)
    v_mfma_f32_32x32x16_bf16 v[64:79], a[144:147], v[96:99], v[64:79]
    s_add_u32 m0, s72, 4096
    ds_read_b64_tr_b16 v[104:105], v14 offset:10240
    ds_read_b64_tr_b16 v[106:107], v14 offset:10752
    buffer_load_dwordx4 v234, s[44:47], s68 offen lds
    s_waitcnt lgkmcnt(2)
    v_mfma_f32_32x32x16_bf16 v[80:95], a[144:147], v[100:103], v[80:95]
    ds_read_b64_tr_b16 v[108:109], v15 offset:10240
    ds_read_b64_tr_b16 v[110:111], v15 offset:10752
    s_waitcnt lgkmcnt(2)
    v_mfma_f32_32x32x16_bf16 v[64:79], a[148:151], v[104:107], v[64:79]
    s_add_u32 m0, s72, 5120
    ds_read_b64_tr_b16 v[96:97], v14 offset:12288
    ds_read_b64_tr_b16 v[98:99], v14 offset:12800
    buffer_load_dwordx4 v235, s[44:47], s68 offen lds
    s_waitcnt lgkmcnt(2)
    v_mfma_f32_32x32x16_bf16 v[80:95], a[148:151], v[108:111], v[80:95]
    ds_read_b64_tr_b16 v[100:101], v15 offset:12288
    ds_read_b64_tr_b16 v[102:103], v15 offset:12800
    s_waitcnt lgkmcnt(2)
    v_mfma_f32_32x32x16_bf16 v[64:79], a[152:155], v[96:99], v[64:79]
    s_add_u32 m0, s72, 6144
    ds_read_b64_tr_b16 v[104:105], v14 offset:14336
    ds_read_b64_tr_b16 v[106:107], v14 offset:14848
    buffer_load_dwordx4 v116, s[44:47], s68 offen lds
    s_waitcnt lgkmcnt(2)
    v_mfma_f32_32x32x16_bf16 v[80:95], a[152:155], v[100:103], v[80:95]
    ds_read_b64_tr_b16 v[108:109], v15 offset:14336
    ds_read_b64_tr_b16 v[110:111], v15 offset:14848
    s_waitcnt lgkmcnt(2)
    v_mfma_f32_32x32x16_bf16 v[64:79], a[156:159], v[104:107], v[64:79]
    s_add_u32 m0, s72, 7168
    ds_read_b64_tr_b16 v[96:97], v14 offset:16384
    ds_read_b64_tr_b16 v[98:99], v14 offset:16896
    buffer_load_dwordx4 v117, s[44:47], s68 offen lds
    s_add_u32 s68, s68, 128
    s_waitcnt lgkmcnt(2)
    v_mfma_f32_32x32x16_bf16 v[80:95], a[156:159], v[108:111], v[80:95]
    ds_read_b64_tr_b16 v[100:101], v15 offset:16384
    ds_read_b64_tr_b16 v[102:103], v15 offset:16896
    s_waitcnt lgkmcnt(2)
    v_mfma_f32_32x32x16_bf16 v[64:79], a[160:163], v[96:99], v[64:79]
    s_add_u32 m0, s72, 8192
    ds_read_b64_tr_b16 v[104:105], v14 offset:18432
    ds_read_b64_tr_b16 v[106:107], v14 offset:18944
    buffer_load_dwordx4 v234, s[44:47], s68 offen lds
    s_waitcnt lgkmcnt(2)
    v_mfma_f32_32x32x16_bf16 v[80:95], a[160:163], v[100:103], v[80:95]
    ds_read_b64_tr_b16 v[108:109], v15 offset:18432
    ds_read_b64_tr_b16 v[110:111], v15 offset:18944
    s_waitcnt lgkmcnt(2)
    v_mfma_f32_32x32x16_bf16 v[64:79], a[164:167], v[104:107], v[64:79]
    s_add_u32 m0, s72, 9216
    ds_read_b64_tr_b16 v[96:97], v14 offset:20480
    ds_read_b64_tr_b16 v[98:99], v14 offset:20992
    buffer_load_dwordx4 v235, s[44:47], s68 offen lds
    s_waitcnt lgkmcnt(2)
    v_mfma_f32_32x32x16_bf16 v[80:95], a[164:167], v[108:111], v[80:95]
    ds_read_b64_tr_b16 v[100:101], v15 offset:20480
    ds_read_b64_tr_b16 v[102:103], v15 offset:20992
    s_waitcnt lgkmcnt(2)
    v_mfma_f32_32x32x16_bf16 v[64:79], a[168:171], v[96:99], v[64:79]
    s_add_u32 m0, s72, 10240
    ds_read_b64_tr_b16 v[104:105], v14 offset:22528
    ds_read_b64_tr_b16 v[106:107], v14 offset:23040
    buffer_load_dwordx4 v116, s[44:47], s68 offen lds
    s_waitcnt lgkmcnt(2)
    v_mfma_f32_32x32x16_bf16 v[80:95], a[168:171], v[100:103], v[80:95]
    ds_read_b64_tr_b16 v[108:109], v15 offset:22528
    ds_read_b64_tr_b16 v[110:111], v15 offset:23040
    s_waitcnt lgkmcnt(2)
    v_mfma_f32_32x32x16_bf16 v[64:79], a[172:175], v[104:107], v[64:79]
    s_add_u32 m0, s72, 11264
    ds_read_b64_tr_b16 v[96:97], v14 offset:24576
    ds_read_b64_tr_b16 v[98:99], v14 offset:25088
    buffer_load_dwordx4 v117, s[44:47], s68 offen lds
    s_add_u32 s68, s68, 128
    s_waitcnt lgkmcnt(2)
    v_mfma_f32_32x32x16_bf16 v[80:95], a[172:175], v[108:111], v[80:95]
    ds_read_b64_tr_b16 v[100:101], v15 offset:24576
    ds_read_b64_tr_b16 v[102:103], v15 offset:25088
    s_waitcnt lgkmcnt(2)
    v_mfma_f32_32x32x16_bf16 v[64:79], a[176:179], v[96:99], v[64:79]
    s_add_u32 m0, s73, 0
    ds_read_b64_tr_b16 v[104:105], v14 offset:26624
    ds_read_b64_tr_b16 v[106:107], v14 offset:27136
    buffer_load_dwordx4 v234, s[44:47], s68 offen lds
    s_waitcnt lgkmcnt(2)
    v_mfma_f32_32x32x16_bf16 v[80:95], a[176:179], v[100:103], v[80:95]
    ds_read_b64_tr_b16 v[108:109], v15 offset:26624
    ds_read_b64_tr_b16 v[110:111], v15 offset:27136
    s_waitcnt vmcnt(9)
    ds_read_b128 a[0:3], v224 offset:0
    s_waitcnt lgkmcnt(3)
    v_mfma_f32_32x32x16_bf16 v[64:79], a[180:183], v[104:107], v[64:79]
    s_add_u32 m0, s73, 1024
    ds_read_b64_tr_b16 v[96:97], v14 offset:28672
    ds_read_b64_tr_b16 v[98:99], v14 offset:29184
    buffer_load_dwordx4 v235, s[44:47], s68 offen lds
    s_waitcnt lgkmcnt(3)
    v_mfma_f32_32x32x16_bf16 v[80:95], a[180:183], v[108:111], v[80:95]
    ds_read_b64_tr_b16 v[100:101], v15 offset:28672
    ds_read_b64_tr_b16 v[102:103], v15 offset:29184
    ds_read_b128 a[4:7], v225 offset:0
    s_waitcnt lgkmcnt(3)
    v_mfma_f32_32x32x16_bf16 v[64:79], a[184:187], v[96:99], v[64:79]
    s_add_u32 m0, s73, 2048
    ds_read_b64_tr_b16 v[104:105], v14 offset:30720
    ds_read_b64_tr_b16 v[106:107], v14 offset:31232
    buffer_load_dwordx4 v116, s[44:47], s68 offen lds
    s_waitcnt lgkmcnt(3)
    v_mfma_f32_32x32x16_bf16 v[80:95], a[184:187], v[100:103], v[80:95]
    ds_read_b64_tr_b16 v[108:109], v15 offset:30720
    ds_read_b64_tr_b16 v[110:111], v15 offset:31232
    ds_read_b128 a[8:11], v226 offset:0
    s_waitcnt lgkmcnt(3)
    v_mfma_f32_32x32x16_bf16 v[64:79], a[188:191], v[104:107], v[64:79]
    s_add_u32 m0, s73, 3072
    ds_read_b64_tr_b16 v[96:97], v14 offset:32768
    ds_read_b64_tr_b16 v[98:99], v14 offset:33280
    buffer_load_dwordx4 v117, s[44:47], s68 offen lds
    s_add_u32 s68, s68, 128
    s_waitcnt lgkmcnt(3)
    v_mfma_f32_32x32x16_bf16 v[80:95], a[188:191], v[108:111], v[80:95]
    ds_read_b64_tr_b16 v[100:101], v15 offset:32768
    ds_read_b64_tr_b16 v[102:103], v15 offset:33280
    ds_read_b128 a[12:15], v227 offset:0
    s_waitcnt lgkmcnt(3)
    v_mfma_f32_32x32x16_bf16 v[64:79], a[192:195], v[96:99], v[64:79]
    s_add_u32 m0, s73, 4096
    ds_read_b64_tr_b16 v[104:105], v14 offset:34816
    ds_read_b64_tr_b16 v[106:107], v14 offset:35328
    buffer_load_dwordx4 v234, s[44:47], s68 offen lds
    s_waitcnt lgkmcnt(3)
    v_mfma_f32_32x32x16_bf16 v[80:95], a[192:195], v[100:103], v[80:95]
    ds_read_b64_tr_b16 v[108:109], v15 offset:34816
    ds_read_b64_tr_b16 v[110:111], v15 offset:35328
    s_waitcnt vmcnt(9)
    ds_read_b128 a[16:19], v224 offset:4096
    s_waitcnt lgkmcnt(3)
    v_mfma_f32_32x32x16_bf16 v[64:79], a[196:199], v[104:107], v[64:79]
    s_add_u32 m0, s73, 5120
    ds_read_b64_tr_b16 v[96:97], v14 offset:36864
    ds_read_b64_tr_b16 v[98:99], v14 offset:37376
    buffer_load_dwordx4 v235, s[44:47], s68 offen lds
    s_waitcnt lgkmcnt(3)
    v_mfma_f32_32x32x16_bf16 v[80:95], a[196:199], v[108:111], v[80:95]
    ds_read_b64_tr_b16 v[100:101], v15 offset:36864
    ds_read_b64_tr_b16 v[102:103], v15 offset:37376
    ds_read_b128 a[20:23], v225 offset:4096
    buffer_load_dwordx2 v[176:177], v250, s[32:35], 0 offen offset:0 sc0 sc1
    s_waitcnt lgkmcnt(3)
    v_mfma_f32_32x32x16_bf16 v[64:79], a[200:203], v[96:99], v[64:79]
    s_add_u32 m0, s73, 6144
    ds_read_b64_tr_b16 v[104:105], v14 offset:38912
    ds_read_b64_tr_b16 v[106:107], v14 offset:39424
    buffer_load_dwordx4 v116, s[44:47], s68 offen lds
    s_waitcnt lgkmcnt(3)
    v_mfma_f32_32x32x16_bf16 v[80:95], a[200:203], v[100:103], v[80:95]
    ds_read_b64_tr_b16 v[108:109], v15 offset:38912
    ds_read_b64_tr_b16 v[110:111], v15 offset:39424
    ds_read_b128 a[24:27], v226 offset:4096
    buffer_load_dwordx2 v[178:179], v250, s[32:35], 0 offen offset:512 sc0 sc1
    s_waitcnt lgkmcnt(3)
    v_mfma_f32_32x32x16_bf16 v[64:79], a[204:207], v[104:107], v[64:79]
    s_add_u32 m0, s73, 7168
    ds_read_b64_tr_b16 v[96:97], v14 offset:40960
    ds_read_b64_tr_b16 v[98:99], v14 offset:41472
    buffer_load_dwordx4 v117, s[44:47], s68 offen lds
    s_add_u32 s68, s68, 128
    s_waitcnt lgkmcnt(3)
    v_mfma_f32_32x32x16_bf16 v[80:95], a[204:207], v[108:111], v[80:95]
    ds_read_b64_tr_b16 v[100:101], v15 offset:40960
    ds_read_b64_tr_b16 v[102:103], v15 offset:41472
    ds_read_b128 a[28:31], v227 offset:4096
    buffer_load_dwordx2 v[180:181], v250, s[32:35], 0 offen offset:1024 sc0 sc1
    s_waitcnt lgkmcnt(3)
    v_mfma_f32_32x32x16_bf16 v[64:79], a[208:211], v[96:99], v[64:79]
    s_add_u32 m0, s72, 0
    ds_read_b64_tr_b16 v[104:105], v14 offset:43008
    ds_read_b64_tr_b16 v[106:107], v14 offset:43520
    buffer_load_dwordx4 v234, s[44:47], s68 offen lds
    s_waitcnt lgkmcnt(3)
    v_mfma_f32_32x32x16_bf16 v[80:95], a[208:211], v[100:103], v[80:95]
    ds_read_b64_tr_b16 v[108:109], v15 offset:43008
    ds_read_b64_tr_b16 v[110:111], v15 offset:43520
    s_waitcnt vmcnt(12)
    ds_read_b128 a[32:35], v224 offset:8192
    buffer_load_dwordx2 v[182:183], v250, s[32:35], 0 offen offset:1536 sc0 sc1
    s_waitcnt lgkmcnt(3)
    v_mfma_f32_32x32x16_bf16 v[64:79], a[212:215], v[104:107], v[64:79]
    s_add_u32 m0, s72, 1024
    ds_read_b64_tr_b16 v[96:97], v14 offset:45056
    ds_read_b64_tr_b16 v[98:99], v14 offset:45568
    buffer_load_dwordx4 v235, s[44:47], s68 offen lds
    s_waitcnt lgkmcnt(3)
    v_mfma_f32_32x32x16_bf16 v[80:95], a[212:215], v[108:111], v[80:95]
    ds_read_b64_tr_b16 v[100:101], v15 offset:45056
    ds_read_b64_tr_b16 v[102:103], v15 offset:45568
    ds_read_b128 a[36:39], v225 offset:8192
    buffer_load_dwordx2 v[184:185], v250, s[32:35], 0 offen offset:2048 sc0 sc1
    s_waitcnt lgkmcnt(3)
    v_mfma_f32_32x32x16_bf16 v[64:79], a[216:219], v[96:99], v[64:79]
    s_add_u32 m0, s72, 2048
    ds_read_b64_tr_b16 v[104:105], v14 offset:47104
    ds_read_b64_tr_b16 v[106:107], v14 offset:47616
    buffer_load_dwordx4 v116, s[44:47], s68 offen lds
    s_waitcnt lgkmcnt(3)
    v_mfma_f32_32x32x16_bf16 v[80:95], a[216:219], v[100:103], v[80:95]
    ds_read_b64_tr_b16 v[108:109], v15 offset:47104
    ds_read_b64_tr_b16 v[110:111], v15 offset:47616
    ds_read_b128 a[40:43], v226 offset:8192
    buffer_load_dwordx2 v[186:187], v250, s[32:35], 0 offen offset:2560 sc0 sc1
    s_waitcnt lgkmcnt(3)
    v_mfma_f32_32x32x16_bf16 v[64:79], a[220:223], v[104:107], v[64:79]
    s_add_u32 m0, s72, 3072
    ds_read_b64_tr_b16 v[96:97], v14 offset:49152
    ds_read_b64_tr_b16 v[98:99], v14 offset:49664
    buffer_load_dwordx4 v117, s[44:47], s68 offen lds
    s_add_u32 s68, s68, 128
    s_waitcnt lgkmcnt(3)
    v_mfma_f32_32x32x16_bf16 v[80:95], a[220:223], v[108:111], v[80:95]
    ds_read_b64_tr_b16 v[100:101], v15 offset:49152
    ds_read_b64_tr_b16 v[102:103], v15 offset:49664
    ds_read_b128 a[44:47], v227 offset:8192
    buffer_load_dwordx2 v[188:189], v250, s[32:35], 0 offen offset:3072 sc0 sc1
    s_waitcnt lgkmcnt(3)
    v_mfma_f32_32x32x16_bf16 v[64:79], a[224:227], v[96:99], v[64:79]
    s_add_u32 m0, s72, 4096
    ds_read_b64_tr_b16 v[104:105], v14 offset:51200
    ds_read_b64_tr_b16 v[106:107], v14 offset:51712
    buffer_load_dwordx4 v234, s[44:47], s68 offen lds
    s_waitcnt lgkmcnt(3)
    v_mfma_f32_32x32x16_bf16 v[80:95], a[224:227], v[100:103], v[80:95]
    ds_read_b64_tr_b16 v[108:109], v15 offset:51200
    ds_read_b64_tr_b16 v[110:111], v15 offset:51712
    s_waitcnt vmcnt(16)
    ds_read_b128 a[48:51], v228 offset:0
    s_waitcnt lgkmcnt(3)
    v_mfma_f32_32x32x16_bf16 v[64:79], a[228:231], v[104:107], v[64:79]
    s_add_u32 m0, s72, 5120
    ds_read_b64_tr_b16 v[96:97], v14 offset:53248
    ds_read_b64_tr_b16 v[98:99], v14 offset:53760
    buffer_load_dwordx4 v235, s[44:47], s68 offen lds
    s_waitcnt lgkmcnt(3)
    v_mfma_f32_32x32x16_bf16 v[80:95], a[228:231], v[108:111], v[80:95]
    ds_read_b64_tr_b16 v[100:101], v15 offset:53248
    ds_read_b64_tr_b16 v[102:103], v15 offset:53760
    ds_read_b128 a[52:55], v229 offset:0
    s_waitcnt lgkmcnt(3)
    v_mfma_f32_32x32x16_bf16 v[64:79], a[232:235], v[96:99], v[64:79]
    s_add_u32 m0, s72, 6144
    ds_read_b64_tr_b16 v[104:105], v14 offset:55296
    ds_read_b64_tr_b16 v[106:107], v14 offset:55808
    buffer_load_dwordx4 v116, s[44:47], s68 offen lds
    s_waitcnt lgkmcnt(3)
    v_mfma_f32_32x32x16_bf16 v[80:95], a[232:235], v[100:103], v[80:95]
    ds_read_b64_tr_b16 v[108:109], v15 offset:55296
    ds_read_b64_tr_b16 v[110:111], v15 offset:55808
    ds_read_b128 a[56:59], v230 offset:0
    s_waitcnt lgkmcnt(3)
    v_mfma_f32_32x32x16_bf16 v[64:79], a[236:239], v[104:107], v[64:79]
    s_add_u32 m0, s72, 7168
    ds_read_b64_tr_b16 v[96:97], v14 offset:57344
    ds_read_b64_tr_b16 v[98:99], v14 offset:57856
    buffer_load_dwordx4 v117, s[44:47], s68 offen lds
    s_add_u32 s68, s68, 128
    s_waitcnt lgkmcnt(3)
    v_mfma_f32_32x32x16_bf16 v[80:95], a[236:239], v[108:111], v[80:95]
    ds_read_b64_tr_b16 v[100:101], v15 offset:57344
    ds_read_b64_tr_b16 v[102:103], v15 offset:57856
    ds_read_b128 a[60:63], v231 offset:0
    s_waitcnt lgkmcnt(3)
    v_mfma_f32_32x32x16_bf16 v[64:79], a[240:243], v[96:99], v[64:79]
    s_add_u32 m0, s72, 8192
    ds_read_b64_tr_b16 v[104:105], v14 offset:59392
    ds_read_b64_tr_b16 v[106:107], v14 offset:59904
    buffer_load_dwordx4 v234, s[44:47], s68 offen lds
    s_waitcnt lgkmcnt(3)
    v_mfma_f32_32x32x16_bf16 v[80:95], a[240:243], v[100:103], v[80:95]
    ds_read_b64_tr_b16 v[108:109], v15 offset:59392
    ds_read_b64_tr_b16 v[110:111], v15 offset:59904
    s_waitcnt vmcnt(14)
    ds_read_b128 a[64:67], v228 offset:4096
    s_waitcnt lgkmcnt(3)
    v_mfma_f32_32x32x16_bf16 v[64:79], a[244:247], v[104:107], v[64:79]
    s_add_u32 m0, s72, 9216
    ds_read_b64_tr_b16 v[96:97], v14 offset:61440
    ds_read_b64_tr_b16 v[98:99], v14 offset:61952
    buffer_load_dwordx4 v235, s[44:47], s68 offen lds
    s_waitcnt lgkmcnt(3)
    v_mfma_f32_32x32x16_bf16 v[80:95], a[244:247], v[108:111], v[80:95]
    ds_read_b64_tr_b16 v[100:101], v15 offset:61440
    ds_read_b64_tr_b16 v[102:103], v15 offset:61952
    ds_read_b128 a[68:71], v229 offset:4096
    s_waitcnt lgkmcnt(3)
    v_mfma_f32_32x32x16_bf16 v[64:79], a[248:251], v[96:99], v[64:79]
    s_add_u32 m0, s72, 10240
    ds_read_b64_tr_b16 v[104:105], v14 offset:63488
    ds_read_b64_tr_b16 v[106:107], v14 offset:64000
    buffer_load_dwordx4 v116, s[44:47], s68 offen lds
    s_waitcnt lgkmcnt(3)
    v_mfma_f32_32x32x16_bf16 v[80:95], a[248:251], v[100:103], v[80:95]
    ds_read_b64_tr_b16 v[108:109], v15 offset:63488
    ds_read_b64_tr_b16 v[110:111], v15 offset:64000
    ds_read_b128 a[72:75], v230 offset:4096
    s_waitcnt lgkmcnt(3)
    v_mfma_f32_32x32x16_bf16 v[64:79], a[252:255], v[104:107], v[64:79]
    s_add_u32 m0, s72, 11264
    s_nop 0
    buffer_load_dwordx4 v117, s[44:47], s68 offen lds
    s_add_u32 s68, s68, 128
    s_waitcnt lgkmcnt(1)
    v_mfma_f32_32x32x16_bf16 v[80:95], a[252:255], v[108:111], v[80:95]
    ds_read_b128 a[76:79], v231 offset:4096
    s_waitcnt lgkmcnt(0)
    s_barrier
    s_waitcnt vmcnt(8)
    v_max_u32 v190, v177, v179
    v_max3_u32 v190, v190, v181, v183
    v_max3_u32 v190, v190, v185, v187
    v_max_u32 v190, v190, v189
    v_cmp_eq_u32 vcc, -1, v190
    s_mov_b32 s69, 0
    s_cbranch_vccz KB_GOT1
KB_POLL1:
    buffer_load_dwordx2 v[176:177], v250, s[32:35], 0 offen offset:0 sc0 sc1
    buffer_load_dwordx2 v[178:179], v250, s[32:35], 0 offen offset:512 sc0 sc1
    buffer_load_dwordx2 v[180:181], v250, s[32:35], 0 offen offset:1024 sc0 sc1
    buffer_load_dwordx2 v[182:183], v250, s[32:35], 0 offen offset:1536 sc0 sc1
    buffer_load_dwordx2 v[184:185], v250, s[32:35], 0 offen offset:2048 sc0 sc1
    buffer_load_dwordx2 v[186:187], v250, s[32:35], 0 offen offset:2560 sc0 sc1
    buffer_load_dwordx2 v[188:189], v250, s[32:35], 0 offen offset:3072 sc0 sc1
    s_waitcnt vmcnt(0)
    v_max_u32 v190, v177, v179
    v_max3_u32 v190, v190, v181, v183
    v_max3_u32 v190, v190, v185, v187
    v_max_u32 v190, v190, v189
    v_cmp_eq_u32 vcc, -1, v190
    s_add_u32 s69, s69, 1
    s_cbranch_vccz KB_GOT1
    s_cmp_lt_u32 s69, 0x40000
    s_cbranch_scc1 KB_POLL1
KB_GOT1:
    v_add_f32 v176, v176, v178
    v_add_f32 v177, v177, v179
    v_add_f32 v176, v176, v180
    v_add_f32 v177, v177, v181
    v_add_f32 v176, v176, v182
    v_add_f32 v177, v177, v183
    v_add_f32 v176, v176, v184
    v_add_f32 v177, v177, v185
    v_add_f32 v176, v176, v186
    v_add_f32 v177, v177, v187
    v_add_f32 v176, v176, v188
    v_add_f32 v177, v177, v189
    s_mov_b32 s69, 0x3a924925
    v_mul_f32 v176, s69, v176
    v_mul_f32 v177, s69, v177
    v_fma_f32 v177, -v176, v176, v177
    v_max_f32 v177, 0, v177
    v_add_f32 v177, s66, v177
    v_rsq_f32 v178, v177
    s_nop 0
    v_mul_f32 v179, v176, v178
    v_sub_f32 v179, 0, v179
    v_mov_b32 v180, v178
    v_mov_b32 v181, v179
    s_cmp_eq_u32 s58, 0
    s_cselect_b64 s[78:79], -1, 0
    v_permlane32_swap_b32 v178, v180
    v_permlane32_swap_b32 v179, v181
    s_nop 1
    v_cndmask_b32 v182, v180, v178, s[78:79]
    v_cndmask_b32 v183, v181, v179, s[78:79]
    v_cndmask_b32 v184, v178, v180, s[78:79]
    v_cndmask_b32 v185, v179, v181, s[78:79]
    v_pk_fma_f32 v[32:33], v[32:33], v[182:183], v[182:183] op_sel:[0,0,1] op_sel_hi:[1,0,1]
    v_pk_fma_f32 v[34:35], v[34:35], v[182:183], v[182:183] op_sel:[0,0,1] op_sel_hi:[1,0,1]
    v_pk_fma_f32 v[36:37], v[36:37], v[182:183], v[182:183] op_sel:[0,0,1] op_sel_hi:[1,0,1]
    v_pk_fma_f32 v[38:39], v[38:39], v[182:183], v[182:183] op_sel:[0,0,1] op_sel_hi:[1,0,1]
    v_pk_fma_f32 v[40:41], v[40:41], v[182:183], v[182:183] op_sel:[0,0,1] op_sel_hi:[1,0,1]
    v_pk_fma_f32 v[42:43], v[42:43], v[182:183], v[182:183] op_sel:[0,0,1] op_sel_hi:[1,0,1]
    v_pk_fma_f32 v[44:45], v[44:45], v[182:183], v[182:183] op_sel:[0,0,1] op_sel_hi:[1,0,1]
    v_pk_fma_f32 v[46:47], v[46:47], v[182:183], v[182:183] op_sel:[0,0,1] op_sel_hi:[1,0,1]
    v_cvt_pk_bf16_f32 v152, v32, v33
    v_cvt_pk_bf16_f32 v153, v34, v35
    v_cvt_pk_bf16_f32 v154, v36, v37
    v_cvt_pk_bf16_f32 v155, v38, v39
    v_cvt_pk_bf16_f32 v156, v40, v41
    v_cvt_pk_bf16_f32 v157, v42, v43
    v_cvt_pk_bf16_f32 v158, v44, v45
    v_cvt_pk_bf16_f32 v159, v46, v47
    v_pk_fma_f32 v[48:49], v[48:49], v[184:185], v[184:185] op_sel:[0,0,1] op_sel_hi:[1,0,1]
    v_pk_fma_f32 v[50:51], v[50:51], v[184:185], v[184:185] op_sel:[0,0,1] op_sel_hi:[1,0,1]
    v_pk_fma_f32 v[52:53], v[52:53], v[184:185], v[184:185] op_sel:[0,0,1] op_sel_hi:[1,0,1]
    v_pk_fma_f32 v[54:55], v[54:55], v[184:185], v[184:185] op_sel:[0,0,1] op_sel_hi:[1,0,1]
    v_pk_fma_f32 v[56:57], v[56:57], v[184:185], v[184:185] op_sel:[0,0,1] op_sel_hi:[1,0,1]
    v_pk_fma_f32 v[58:59], v[58:59], v[184:185], v[184:185] op_sel:[0,0,1] op_sel_hi:[1,0,1]
    v_pk_fma_f32 v[60:61], v[60:61], v[184:185], v[184:185] op_sel:[0,0,1] op_sel_hi:[1,0,1]
    v_pk_fma_f32 v[62:63], v[62:63], v[184:185], v[184:185] op_sel:[0,0,1] op_sel_hi:[1,0,1]
    v_cvt_pk_bf16_f32 v160, v48, v49
    v_cvt_pk_bf16_f32 v161, v50, v51
    v_cvt_pk_bf16_f32 v162, v52, v53
    v_cvt_pk_bf16_f32 v163, v54, v55
    v_cvt_pk_bf16_f32 v164, v56, v57
    v_cvt_pk_bf16_f32 v165, v58, v59
    v_cvt_pk_bf16_f32 v166, v60, v61
    v_cvt_pk_bf16_f32 v167, v62, v63
    ds_write_b64 v240, v[152:153]
    ds_write_b64 v244, v[160:161]
    ds_write_b64 v241, v[154:155]
    ds_write_b64 v245, v[162:163]
    ds_write_b64 v242, v[156:157]
    ds_write_b64 v246, v[164:165]
    ds_write_b64 v243, v[158:159]
    ds_write_b64 v247, v[166:167]
    s_waitcnt lgkmcnt(0)
    ds_read_b64_tr_b16 v[208:209], v248 offset:0
    ds_read_b64_tr_b16 v[210:211], v249 offset:0
    ds_read_b64_tr_b16 v[212:213], v248 offset:1024
    ds_read_b64_tr_b16 v[214:215], v249 offset:1024
    ds_read_b64_tr_b16 v[216:217], v248 offset:2048
    ds_read_b64_tr_b16 v[218:219], v249 offset:2048
    ds_read_b64_tr_b16 v[220:221], v248 offset:3072
    ds_read_b64_tr_b16 v[222:223], v249 offset:3072
    s_waitcnt lgkmcnt(0)
    buffer_store_dwordx4 v[208:211], v4, s[40:43], s83 offen offset:0 sc0 sc1
    buffer_store_dwordx4 v[212:215], v4, s[40:43], s83 offen offset:1024 sc0 sc1
    buffer_store_dwordx4 v[216:219], v4, s[40:43], s83 offen offset:2048 sc0 sc1
    buffer_store_dwordx4 v[220:223], v4, s[40:43], s83 offen offset:3072 sc0 sc1
    s_lshl_b32 s69, s50, 12
    s_sub_u32 s73, s73, s69
    v_subrev_u32 v228, s69, v228
    v_subrev_u32 v229, s69, v229
    v_subrev_u32 v230, s69, v230
    v_subrev_u32 v231, s69, v231
    s_add_u32 m0, s74, 0
    s_nop 0
    buffer_load_dwordx4 v234, s[44:47], s68 offen lds
    s_add_u32 m0, s74, 1024
    s_nop 0
    buffer_load_dwordx4 v235, s[44:47], s68 offen lds
    s_add_u32 m0, s74, 2048
    s_nop 0
    buffer_load_dwordx4 v116, s[44:47], s68 offen lds
    s_add_u32 m0, s74, 3072
    s_nop 0
    buffer_load_dwordx4 v117, s[44:47], s68 offen lds
    s_add_u32 s68, s68, 128
    s_add_u32 m0, s74, 4096
    s_nop 0
    buffer_load_dwordx4 v234, s[44:47], s68 offen lds
    s_add_u32 m0, s74, 5120
    s_nop 0
    buffer_load_dwordx4 v235, s[44:47], s68 offen lds
    s_add_u32 m0, s74, 6144
    s_nop 0
    buffer_load_dwordx4 v116, s[44:47], s68 offen lds
    s_add_u32 m0, s74, 7168
    s_nop 0
    buffer_load_dwordx4 v117, s[44:47], s68 offen lds
    s_add_u32 s68, s68, 128
    s_add_u32 m0, s74, 8192
    s_nop 0
    buffer_load_dwordx4 v234, s[44:47], s68 offen lds
    s_add_u32 m0, s74, 9216
    s_nop 0
    buffer_load_dwordx4 v235, s[44:47], s68 offen lds
    s_add_u32 m0, s74, 10240
    s_nop 0
    buffer_load_dwordx4 v116, s[44:47], s68 offen lds
    s_add_u32 m0, s74, 11264
    s_nop 0
    buffer_load_dwordx4 v117, s[44:47], s68 offen lds
    s_add_u32 s68, s68, 128
    v_mov_b32 v194, 1
    s_waitcnt vmcnt(12)
    s_barrier
    s_cmp_eq_u32 s50, 0
    s_cbranch_scc0 KB_NOFLAGC
    buffer_store_dword v194, v255, s[36:39], 0 offen sc0 sc1
KB_NOFLAGC:
    ds_read_b128 a[80:83], v224 offset:0
    ds_read_b128 a[84:87], v225 offset:0
    ds_read_b128 a[88:91], v226 offset:0
    ds_read_b128 a[92:95], v227 offset:0
    ds_read_b128 a[96:99], v224 offset:4096
    ds_read_b128 a[100:103], v225 offset:4096
    ds_read_b128 a[104:107], v226 offset:4096
    ds_read_b128 a[108:111], v227 offset:4096
    ds_read_b128 a[112:115], v224 offset:8192
    ds_read_b128 a[116:119], v225 offset:8192
    ds_read_b128 a[120:123], v226 offset:8192
    ds_read_b128 a[124:127], v227 offset:8192
    s_mov_b32 s28, s6
    s_mov_b32 s29, s7
    s_mov_b32 s30, 4096
    s_mov_b32 s31, 0x00020000
    s_lshl_b32 s69, s51, 7
    s_lshl_b32 s80, s58, 6
    s_add_u32 s69, s69, s80
    v_lshlrev_b32 v22, 1, v5
    v_add_u32 v22, s69, v22
    buffer_load_ushort v23, v22, s[28:31], 0 offen
    v_pk_mul_f32 v[64:65], v[64:65], v[18:19] op_sel_hi:[1,0]
    v_pk_mul_f32 v[66:67], v[66:67], v[18:19] op_sel_hi:[1,0]
    v_pk_mul_f32 v[68:69], v[68:69], v[18:19] op_sel_hi:[1,0]
    v_pk_mul_f32 v[70:71], v[70:71], v[18:19] op_sel_hi:[1,0]
    v_pk_mul_f32 v[72:73], v[72:73], v[18:19] op_sel_hi:[1,0]
    v_pk_mul_f32 v[74:75], v[74:75], v[18:19] op_sel_hi:[1,0]
    v_pk_mul_f32 v[76:77], v[76:77], v[18:19] op_sel_hi:[1,0]
    v_pk_mul_f32 v[78:79], v[78:79], v[18:19] op_sel_hi:[1,0]
    s_add_u32 m0, s74, 12288
    v_pk_fma_f32 v[64:65], v[136:137], v[18:19], v[64:65] op_sel:[0,1,0] op_sel_hi:[1,1,1]
    buffer_load_dwordx4 v234, s[44:47], s68 offen lds
    v_pk_fma_f32 v[66:67], v[138:139], v[18:19], v[66:67] op_sel:[0,1,0] op_sel_hi:[1,1,1]
    v_pk_fma_f32 v[68:69], v[140:141], v[18:19], v[68:69] op_sel:[0,1,0] op_sel_hi:[1,1,1]
    v_pk_fma_f32 v[70:71], v[142:143], v[18:19], v[70:71] op_sel:[0,1,0] op_sel_hi:[1,1,1]
    v_pk_fma_f32 v[72:73], v[144:145], v[18:19], v[72:73] op_sel:[0,1,0] op_sel_hi:[1,1,1]
    v_pk_fma_f32 v[74:75], v[146:147], v[18:19], v[74:75] op_sel:[0,1,0] op_sel_hi:[1,1,1]
    v_pk_fma_f32 v[76:77], v[148:149], v[18:19], v[76:77] op_sel:[0,1,0] op_sel_hi:[1,1,1]
    v_pk_fma_f32 v[78:79], v[150:151], v[18:19], v[78:79] op_sel:[0,1,0] op_sel_hi:[1,1,1]
    v_pk_mul_f32 v[80:81], v[80:81], v[24:25] op_sel_hi:[1,0]
    s_add_u32 m0, s74, 13312
    v_pk_mul_f32 v[82:83], v[82:83], v[24:25] op_sel_hi:[1,0]
    buffer_load_dwordx4 v235, s[44:47], s68 offen lds
    v_pk_mul_f32 v[84:85], v[84:85], v[24:25] op_sel_hi:[1,0]
    v_pk_mul_f32 v[86:87], v[86:87], v[24:25] op_sel_hi:[1,0]
    v_pk_mul_f32 v[88:89], v[88:89], v[24:25] op_sel_hi:[1,0]
    v_pk_mul_f32 v[90:91], v[90:91], v[24:25] op_sel_hi:[1,0]
    v_pk_mul_f32 v[92:93], v[92:93], v[24:25] op_sel_hi:[1,0]
    v_pk_mul_f32 v[94:95], v[94:95], v[24:25] op_sel_hi:[1,0]
    v_pk_fma_f32 v[80:81], v[136:137], v[24:25], v[80:81] op_sel:[0,1,0] op_sel_hi:[1,1,1]
    v_pk_fma_f32 v[82:83], v[138:139], v[24:25], v[82:83] op_sel:[0,1,0] op_sel_hi:[1,1,1]
    s_add_u32 m0, s74, 14336
    v_pk_fma_f32 v[84:85], v[140:141], v[24:25], v[84:85] op_sel:[0,1,0] op_sel_hi:[1,1,1]
    buffer_load_dwordx4 v116, s[44:47], s68 offen lds
    v_pk_fma_f32 v[86:87], v[142:143], v[24:25], v[86:87] op_sel:[0,1,0] op_sel_hi:[1,1,1]
    v_pk_fma_f32 v[88:89], v[144:145], v[24:25], v[88:89] op_sel:[0,1,0] op_sel_hi:[1,1,1]
    v_pk_fma_f32 v[90:91], v[146:147], v[24:25], v[90:91] op_sel:[0,1,0] op_sel_hi:[1,1,1]
    v_pk_fma_f32 v[92:93], v[148:149], v[24:25], v[92:93] op_sel:[0,1,0] op_sel_hi:[1,1,1]
    v_pk_fma_f32 v[94:95], v[150:151], v[24:25], v[94:95] op_sel:[0,1,0] op_sel_hi:[1,1,1]
    v_pk_mul_f32 v[152:153], v[64:65], v[64:65]
    v_pk_mul_f32 v[154:155], v[66:67], v[66:67]
    v_pk_mul_f32 v[156:157], v[68:69], v[68:69]
    s_add_u32 m0, s74, 15360
    v_pk_mul_f32 v[158:159], v[70:71], v[70:71]
    buffer_load_dwordx4 v117, s[44:47], s68 offen lds
    s_add_u32 s68, s68, 128
    v_pk_mul_f32 v[160:161], v[72:73], v[72:73]
    v_pk_mul_f32 v[162:163], v[74:75], v[74:75]
    v_pk_mul_f32 v[164:165], v[76:77], v[76:77]
    v_pk_mul_f32 v[166:167], v[78:79], v[78:79]
    v_pk_mul_f32 v[168:169], v[80:81], v[80:81]
    v_pk_mul_f32 v[170:171], v[82:83], v[82:83]
    v_pk_mul_f32 v[172:173], v[84:85], v[84:85]
    v_pk_mul_f32 v[174:175], v[86:87], v[86:87]
    s_add_u32 m0, s73, 0
    v_pk_mul_f32 v[176:177], v[88:89], v[88:89]
    buffer_load_dwordx4 v234, s[44:47], s68 offen lds
    v_pk_mul_f32 v[178:179], v[90:91], v[90:91]
    v_pk_mul_f32 v[180:181], v[92:93], v[92:93]
    v_pk_mul_f32 v[182:183], v[94:95], v[94:95]
    v_pk_fma_f32 v[152:153], v[152:153], v[28:29], v[26:27]
    v_pk_fma_f32 v[154:155], v[154:155], v[28:29], v[26:27]
    v_pk_fma_f32 v[156:157], v[156:157], v[28:29], v[26:27]
    v_pk_fma_f32 v[158:159], v[158:159], v[28:29], v[26:27]
    v_pk_fma_f32 v[160:161], v[160:161], v[28:29], v[26:27]
    s_add_u32 m0, s73, 1024
    v_pk_fma_f32 v[162:163], v[162:163], v[28:29], v[26:27]
    buffer_load_dwordx4 v235, s[44:47], s68 offen lds
    v_pk_fma_f32 v[164:165], v[164:165], v[28:29], v[26:27]
    v_pk_fma_f32 v[166:167], v[166:167], v[28:29], v[26:27]
    v_pk_fma_f32 v[168:169], v[168:169], v[28:29], v[26:27]
    v_pk_fma_f32 v[170:171], v[170:171], v[28:29], v[26:27]
    v_pk_fma_f32 v[172:173], v[172:173], v[28:29], v[26:27]
    v_pk_fma_f32 v[174:175], v[174:175], v[28:29], v[26:27]
    v_pk_fma_f32 v[176:177], v[176:177], v[28:29], v[26:27]
    v_pk_fma_f32 v[178:179], v[178:179], v[28:29], v[26:27]
    s_add_u32 m0, s73, 2048
    v_pk_fma_f32 v[180:181], v[180:181], v[28:29], v[26:27]
    buffer_load_dwordx4 v116, s[44:47], s68 offen lds
    v_pk_fma_f32 v[182:183], v[182:183], v[28:29], v[26:27]
    v_pk_mul_f32 v[152:153], v[152:153], v[64:65]
    v_pk_mul_f32 v[154:155], v[154:155], v[66:67]
    v_pk_mul_f32 v[156:157], v[156:157], v[68:69]
    v_pk_mul_f32 v[158:159], v[158:159], v[70:71]
    v_pk_mul_f32 v[160:161], v[160:161], v[72:73]
    v_pk_mul_f32 v[162:163], v[162:163], v[74:75]
    v_pk_mul_f32 v[164:165], v[164:165], v[76:77]
    s_add_u32 m0, s73, 3072
    v_pk_mul_f32 v[166:167], v[166:167], v[78:79]
    buffer_load_dwordx4 v117, s[44:47], s68 offen lds
    s_add_u32 s68, s68, 128
    v_pk_mul_f32 v[168:169], v[168:169], v[80:81]
    v_pk_mul_f32 v[170:171], v[170:171], v[82:83]
    v_pk_mul_f32 v[172:173], v[172:173], v[84:85]
    v_pk_mul_f32 v[174:175], v[174:175], v[86:87]
    v_pk_mul_f32 v[176:177], v[176:177], v[88:89]
    v_pk_mul_f32 v[178:179], v[178:179], v[90:91]
    v_pk_mul_f32 v[180:181], v[180:181], v[92:93]
    v_pk_mul_f32 v[182:183], v[182:183], v[94:95]
    s_waitcnt lgkmcnt(0)
    s_add_u32 m0, s72, 0
    v_exp_f32 v152, v152
    buffer_load_dwordx4 v234, s[44:47], s68 offen lds
    v_exp_f32 v153, v153
    v_exp_f32 v154, v154
    v_exp_f32 v155, v155
    v_exp_f32 v156, v156
    v_exp_f32 v157, v157
    v_exp_f32 v158, v158
    v_exp_f32 v159, v159
    v_exp_f32 v160, v160
    s_add_u32 m0, s72, 1024
    v_exp_f32 v161, v161
    buffer_load_dwordx4 v235, s[44:47], s68 offen lds
    v_exp_f32 v162, v162
    v_exp_f32 v163, v163
    v_exp_f32 v164, v164
    v_exp_f32 v165, v165
    v_exp_f32 v166, v166
    v_exp_f32 v167, v167
    v_exp_f32 v168, v168
    v_exp_f32 v169, v169
    s_add_u32 m0, s72, 2048
    v_exp_f32 v170, v170
    buffer_load_dwordx4 v116, s[44:47], s68 offen lds
    v_exp_f32 v171, v171
    v_exp_f32 v172, v172
    v_exp_f32 v173, v173
    v_exp_f32 v174, v174
    v_exp_f32 v175, v175
    v_exp_f32 v176, v176
    v_exp_f32 v177, v177
    v_exp_f32 v178, v178
    s_add_u32 m0, s72, 3072
    v_exp_f32 v179, v179
    buffer_load_dwordx4 v117, s[44:47], s68 offen lds
    s_add_u32 s68, s68, 128
    v_exp_f32 v180, v180
    v_exp_f32 v181, v181
    v_exp_f32 v182, v182
    v_exp_f32 v183, v183
    v_pk_add_f32 v[152:153], v[152:153], v[30:31]
    v_pk_add_f32 v[154:155], v[154:155], v[30:31]
    v_pk_add_f32 v[156:157], v[156:157], v[30:31]
    v_pk_add_f32 v[158:159], v[158:159], v[30:31]
    s_add_u32 m0, s72, 4096
    v_pk_add_f32 v[160:161], v[160:161], v[30:31]
    buffer_load_dwordx4 v234, s[44:47], s68 offen lds
    v_pk_add_f32 v[162:163], v[162:163], v[30:31]
    v_pk_add_f32 v[164:165], v[164:165], v[30:31]
    v_pk_add_f32 v[166:167], v[166:167], v[30:31]
    v_pk_add_f32 v[168:169], v[168:169], v[30:31]
    v_pk_add_f32 v[170:171], v[170:171], v[30:31]
    v_pk_add_f32 v[172:173], v[172:173], v[30:31]
    v_pk_add_f32 v[174:175], v[174:175], v[30:31]
    v_pk_add_f32 v[176:177], v[176:177], v[30:31]
    s_add_u32 m0, s72, 5120
    v_pk_add_f32 v[178:179], v[178:179], v[30:31]
    buffer_load_dwordx4 v235, s[44:47], s68 offen lds
    v_pk_add_f32 v[180:181], v[180:181], v[30:31]
    v_pk_add_f32 v[182:183], v[182:183], v[30:31]
    v_rcp_f32 v152, v152
    v_rcp_f32 v153, v153
    v_rcp_f32 v154, v154
    v_rcp_f32 v155, v155
    v_rcp_f32 v156, v156
    v_rcp_f32 v157, v157
    s_add_u32 m0, s72, 6144
    v_rcp_f32 v158, v158
    buffer_load_dwordx4 v116, s[44:47], s68 offen lds
    v_rcp_f32 v159, v159
    v_rcp_f32 v160, v160
    v_rcp_f32 v161, v161
    v_rcp_f32 v162, v162
    v_rcp_f32 v163, v163
    v_rcp_f32 v164, v164
    v_rcp_f32 v165, v165
    v_rcp_f32 v166, v166
    s_add_u32 m0, s72, 7168
    v_rcp_f32 v167, v167
    buffer_load_dwordx4 v117, s[44:47], s68 offen lds
    s_add_u32 s68, s68, 128
    v_rcp_f32 v168, v168
    v_rcp_f32 v169, v169
    v_rcp_f32 v170, v170
    v_rcp_f32 v171, v171
    v_rcp_f32 v172, v172
    v_rcp_f32 v173, v173
    v_rcp_f32 v174, v174
    v_rcp_f32 v175, v175
    s_add_u32 m0, s72, 8192
    v_rcp_f32 v176, v176
    buffer_load_dwordx4 v234, s[44:47], s68 offen lds
    v_rcp_f32 v177, v177
    v_rcp_f32 v178, v178
    v_rcp_f32 v179, v179
    v_rcp_f32 v180, v180
    v_rcp_f32 v181, v181
    v_rcp_f32 v182, v182
    v_rcp_f32 v183, v183
    v_pk_mul_f32 v[64:65], v[64:65], v[152:153]
    s_add_u32 m0, s72, 9216
    v_pk_mul_f32 v[66:67], v[66:67], v[154:155]
    buffer_load_dwordx4 v235, s[44:47], s68 offen lds
    v_pk_mul_f32 v[68:69], v[68:69], v[156:157]
    v_pk_mul_f32 v[70:71], v[70:71], v[158:159]
    v_pk_mul_f32 v[72:73], v[72:73], v[160:161]
    v_pk_mul_f32 v[74:75], v[74:75], v[162:163]
    v_pk_mul_f32 v[76:77], v[76:77], v[164:165]
    v_pk_mul_f32 v[78:79], v[78:79], v[166:167]
    v_pk_mul_f32 v[80:81], v[80:81], v[168:169]
    v_pk_mul_f32 v[82:83], v[82:83], v[170:171]
    s_add_u32 m0, s72, 10240
    v_pk_mul_f32 v[84:85], v[84:85], v[172:173]
    buffer_load_dwordx4 v116, s[44:47], s68 offen lds
    v_pk_mul_f32 v[86:87], v[86:87], v[174:175]
    v_pk_mul_f32 v[88:89], v[88:89], v[176:177]
    v_pk_mul_f32 v[90:91], v[90:91], v[178:179]
    v_pk_mul_f32 v[92:93], v[92:93], v[180:181]
    v_pk_mul_f32 v[94:95], v[94:95], v[182:183]
    v_cvt_pk_bf16_f32 v152, v64, v65
    v_cvt_pk_bf16_f32 v153, v66, v67
    v_cvt_pk_bf16_f32 v154, v68, v69
    s_add_u32 m0, s72, 11264
    v_cvt_pk_bf16_f32 v155, v70, v71
    buffer_load_dwordx4 v117, s[44:47], s68 offen lds
    s_add_u32 s68, s68, 128
    v_cvt_pk_bf16_f32 v156, v72, v73
    v_cvt_pk_bf16_f32 v157, v74, v75
    v_cvt_pk_bf16_f32 v158, v76, v77
    v_cvt_pk_bf16_f32 v159, v78, v79
    v_cvt_pk_bf16_f32 v160, v80, v81
    v_cvt_pk_bf16_f32 v161, v82, v83
    v_cvt_pk_bf16_f32 v162, v84, v85
    v_cvt_pk_bf16_f32 v163, v86, v87
    v_cvt_pk_bf16_f32 v164, v88, v89
    v_cvt_pk_bf16_f32 v165, v90, v91
    v_cvt_pk_bf16_f32 v166, v92, v93
    v_cvt_pk_bf16_f32 v167, v94, v95
    s_lshl_b32 s69, s52, 7
    v_lshlrev_b32 v16, 2, v5
    v_add_u32 v16, s69, v16
    buffer_load_dword v17, v16, s[36:39], 0 offen sc0 sc1
    s_lshl_b32 s69, s50, 12
    s_lshl_b32 s80, s58, 11
    s_add_u32 s69, s69, s80
    s_add_u32 s69, s69, 135168
    v_add_u32 v176, s69, v4
    v_xor_b32 v177, 2048, v176
    ds_write_b128 v176, v[152:155]
    ds_write_b128 v176, v[156:159] offset:1024
    ds_write_b128 v177, v[160:163]
    ds_write_b128 v177, v[164:167] offset:1024
    s_waitcnt vmcnt(30)
    ds_read_b128 a[128:131], v236 offset:0
    ds_read_b128 a[132:135], v237 offset:0
    ds_read_b128 a[136:139], v238 offset:0
    ds_read_b128 a[140:143], v239 offset:0
    s_waitcnt vmcnt(26)
    ds_read_b128 a[144:147], v236 offset:4096
    ds_read_b128 a[148:151], v237 offset:4096
    ds_read_b128 a[152:155], v238 offset:4096
    ds_read_b128 a[156:159], v239 offset:4096
    s_waitcnt vmcnt(22)
    ds_read_b128 a[160:163], v236 offset:8192
    ds_read_b128 a[164:167], v237 offset:8192
    ds_read_b128 a[168:171], v238 offset:8192
    ds_read_b128 a[172:175], v239 offset:8192
    s_waitcnt vmcnt(17)
    ds_read_b128 a[176:179], v236 offset:12288
    ds_read_b128 a[180:183], v237 offset:12288
    ds_read_b128 a[184:187], v238 offset:12288
    ds_read_b128 a[188:191], v239 offset:12288
    s_waitcnt vmcnt(13)
    ds_read_b128 a[192:195], v228 offset:0
    ds_read_b128 a[196:199], v229 offset:0
    ds_read_b128 a[200:203], v230 offset:0
    ds_read_b128 a[204:207], v231 offset:0
    s_waitcnt vmcnt(9)
    ds_read_b128 a[208:211], v224 offset:0
    ds_read_b128 a[212:215], v225 offset:0
    ds_read_b128 a[216:219], v226 offset:0
    ds_read_b128 a[220:223], v227 offset:0
    s_waitcnt vmcnt(5)
    ds_read_b128 a[224:227], v224 offset:4096
    ds_read_b128 a[228:231], v225 offset:4096
    ds_read_b128 a[232:235], v226 offset:4096
    ds_read_b128 a[236:239], v227 offset:4096
    s_waitcnt vmcnt(1)
    ds_read_b128 a[240:243], v224 offset:8192
    ds_read_b128 a[244:247], v225 offset:8192
    ds_read_b128 a[248:251], v226 offset:8192
    ds_read_b128 a[252:255], v227 offset:8192
    s_lshl_b32 s59, s50, 10
    s_lshl_b32 s60, s67, 12
    s_lshl_b32 s69, s64, 13
    s_lshl_b32 s80, s64, 11
    s_add_u32 s81, s69, s80
    v_add_u32 v7, s81, v4
    s_xor_b32 s80, s80, 2048
    s_add_u32 s81, s69, s80
    v_add_u32 v8, s81, v4
    v_add_u32 v11, 0x10000, v7
    v_add_u32 v12, 0x10000, v8
    v_lshlrev_b32 v23, 16, v23
    s_cmp_eq_u32 s64, 0
    s_cselect_b64 s[78:79], -1, 0
    s_nop 1
    v_cndmask_b32 v128, 0, v23, s[78:79]
    v_mov_b32 v129, v128
    v_mov_b32 v130, v128
    v_mov_b32 v131, v128
    v_mov_b32 v132, v128
    v_mov_b32 v133, v128
    v_mov_b32 v134, v128
    v_mov_b32 v135, v128
    v_mov_b32 v136, v128
    v_mov_b32 v137, v128
    v_mov_b32 v138, v128
    v_mov_b32 v139, v128
    v_mov_b32 v140, v128
    v_mov_b32 v141, v128
    v_mov_b32 v142, v128
    v_mov_b32 v143, v128
    s_waitcnt vmcnt(0)
    v_cmp_eq_u32 vcc, 0, v17
    s_mov_b32 s69, 0
    s_cbranch_vccz KB_GOTC
KB_POLLC:
    buffer_load_dword v17, v16, s[36:39], 0 offen sc0 sc1
    s_waitcnt vmcnt(0)
    v_cmp_eq_u32 vcc, 0, v17
    s_add_u32 s69, s69, 1
    s_cbranch_vccz KB_GOTC
    s_cmp_lt_u32 s69, 0x40000
    s_cbranch_scc1 KB_POLLC
KB_GOTC:
    s_waitcnt vmcnt(0) lgkmcnt(0)
    s_barrier
    v_add_u32 v13, 0x10000, v4
    s_add_u32 m0, s59, 0
    s_nop 0
    buffer_load_dwordx4 v4, s[40:43], s60 offen lds
    s_add_u32 m0, s59, 3072
    s_nop 0
    buffer_load_dwordx4 v4, s[40:43], s60 offen offset:1024 lds
    s_add_u32 m0, s59, 8192
    s_nop 0
    buffer_load_dwordx4 v13, s[40:43], s60 offen lds
    s_add_u32 m0, s59, 11264
    s_nop 0
    buffer_load_dwordx4 v13, s[40:43], s60 offen offset:1024 lds
    s_add_u32 s60, s60, 2048
    s_add_u32 m0, s59, 16384
    s_nop 0
    buffer_load_dwordx4 v4, s[40:43], s60 offen lds
    s_add_u32 m0, s59, 19456
    s_nop 0
    buffer_load_dwordx4 v4, s[40:43], s60 offen offset:1024 lds
    s_add_u32 m0, s59, 24576
    s_nop 0
    buffer_load_dwordx4 v13, s[40:43], s60 offen lds
    s_add_u32 m0, s59, 27648
    s_nop 0
    buffer_load_dwordx4 v13, s[40:43], s60 offen offset:1024 lds
    s_add_u32 s60, s60, 2048
    s_add_u32 m0, s59, 32768
    s_nop 0
    buffer_load_dwordx4 v4, s[40:43], s60 offen lds
    s_add_u32 m0, s59, 35840
    s_nop 0
    buffer_load_dwordx4 v4, s[40:43], s60 offen offset:1024 lds
    s_add_u32 m0, s59, 40960
    s_nop 0
    buffer_load_dwordx4 v13, s[40:43], s60 offen lds
    s_add_u32 m0, s59, 44032
    s_nop 0
    buffer_load_dwordx4 v13, s[40:43], s60 offen offset:1024 lds
    s_add_u32 s60, s60, 2048
    s_add_u32 m0, s59, 49152
    s_nop 0
    buffer_load_dwordx4 v4, s[40:43], s60 offen lds
    s_add_u32 m0, s59, 52224
    s_nop 0
    buffer_load_dwordx4 v4, s[40:43], s60 offen offset:1024 lds
    s_add_u32 m0, s59, 57344
    s_nop 0
    buffer_load_dwordx4 v13, s[40:43], s60 offen lds
    s_add_u32 m0, s59, 60416
    s_nop 0
    buffer_load_dwordx4 v13, s[40:43], s60 offen offset:1024 lds
    s_add_u32 s60, s60, 2048
    s_waitcnt vmcnt(12)
    s_barrier
    ds_read_b128 v[96:99], v7 offset:0
    ds_read_b128 v[100:103], v7 offset:1024
    ds_read_b128 v[104:107], v8 offset:0
    ds_read_b128 v[108:111], v8 offset:1024
    s_waitcnt lgkmcnt(2)
    v_mfma_f32_32x32x16_bf16 v[32:47], v[96:99], a[0:3], v[128:143]
    ds_read_b128 v[112:115], v7 offset:4096
    v_mfma_f32_32x32x16_bf16 v[48:63], v[100:103], a[0:3], v[128:143]
    ds_read_b128 v[116:119], v7 offset:5120
    s_waitcnt lgkmcnt(2)
    v_mfma_f32_32x32x16_bf16 v[64:79], v[104:107], a[0:3], v[128:143]
    ds_read_b128 v[120:123], v8 offset:4096
    v_mfma_f32_32x32x16_bf16 v[80:95], v[108:111], a[0:3], v[128:143]
    ds_read_b128 v[124:127], v8 offset:5120
    s_waitcnt lgkmcnt(2)
    v_mfma_f32_32x32x16_bf16 v[32:47], v[112:115], a[4:7], v[32:47]
    s_waitcnt vmcnt(8)
    s_barrier
    ds_read_b128 v[96:99], v7 offset:16384
    v_mfma_f32_32x32x16_bf16 v[48:63], v[116:119], a[4:7], v[48:63]
    s_add_u32 m0, s59, 65536
    ds_read_b128 v[100:103], v7 offset:17408
    buffer_load_dwordx4 v4, s[40:43], s60 offen lds
    s_waitcnt lgkmcnt(2)
    v_mfma_f32_32x32x16_bf16 v[64:79], v[120:123], a[4:7], v[64:79]
    ds_read_b128 v[104:107], v8 offset:16384
    v_mfma_f32_32x32x16_bf16 v[80:95], v[124:127], a[4:7], v[80:95]
    s_add_u32 m0, s59, 68608
    ds_read_b128 v[108:111], v8 offset:17408
    buffer_load_dwordx4 v4, s[40:43], s60 offen offset:1024 lds
    s_waitcnt lgkmcnt(2)
    v_mfma_f32_32x32x16_bf16 v[32:47], v[96:99], a[8:11], v[32:47]
    ds_read_b128 v[112:115], v7 offset:20480
    s_lshr_b32 s53, s50, 1
    v_mfma_f32_32x32x16_bf16 v[48:63], v[100:103], a[8:11], v[48:63]
    s_add_u32 m0, s59, 73728
    ds_read_b128 v[116:119], v7 offset:21504
    buffer_load_dwordx4 v13, s[40:43], s60 offen lds
    s_waitcnt lgkmcnt(2)
    v_mfma_f32_32x32x16_bf16 v[64:79], v[104:107], a[8:11], v[64:79]
    ds_read_b128 v[120:123], v8 offset:20480
    s_and_b32 s54, s50, 1
    v_mfma_f32_32x32x16_bf16 v[80:95], v[108:111], a[8:11], v[80:95]
    s_add_u32 m0, s59, 76800
    ds_read_b128 v[124:127], v8 offset:21504
    buffer_load_dwordx4 v13, s[40:43], s60 offen offset:1024 lds
    s_add_u32 s60, s60, 2048
    s_waitcnt lgkmcnt(2)
    v_mfma_f32_32x32x16_bf16 v[32:47], v[112:115], a[12:15], v[32:47]
    s_waitcnt vmcnt(8)
    s_barrier
    ds_read_b128 v[96:99], v7 offset:32768
    s_mul_i32 s55, s50, 14336
    v_mfma_f32_32x32x16_bf16 v[48:63], v[116:119], a[12:15], v[48:63]
    s_add_u32 m0, s59, 81920
    ds_read_b128 v[100:103], v7 offset:33792
    buffer_load_dwordx4 v4, s[40:43], s60 offen lds
    s_waitcnt lgkmcnt(2)
    v_mfma_f32_32x32x16_bf16 v[64:79], v[120:123], a[12:15], v[64:79]
    ds_read_b128 v[104:107], v8 offset:32768
    s_lshl_b32 s56, s76, 1
    v_mfma_f32_32x32x16_bf16 v[80:95], v[124:127], a[12:15], v[80:95]
    s_add_u32 m0, s59, 84992
    ds_read_b128 v[108:111], v8 offset:33792
    buffer_load_dwordx4 v4, s[40:43], s60 offen offset:1024 lds
    s_waitcnt lgkmcnt(2)
    v_mfma_f32_32x32x16_bf16 v[32:47], v[96:99], a[16:19], v[32:47]
    ds_read_b128 v[112:115], v7 offset:36864
    s_add_u32 s48, s56, s53
    v_mfma_f32_32x32x16_bf16 v[48:63], v[100:103], a[16:19], v[48:63]
    s_add_u32 m0, s59, 90112
    ds_read_b128 v[116:119], v7 offset:37888
    buffer_load_dwordx4 v13, s[40:43], s60 offen lds
    s_waitcnt lgkmcnt(2)
    v_mfma_f32_32x32x16_bf16 v[64:79], v[104:107], a[16:19], v[64:79]
    ds_read_b128 v[120:123], v8 offset:36864
    s_xor_b32 s49, s53, 1
    v_mfma_f32_32x32x16_bf16 v[80:95], v[108:111], a[16:19], v[80:95]
    s_add_u32 m0, s59, 93184
    ds_read_b128 v[124:127], v8 offset:37888
    buffer_load_dwordx4 v13, s[40:43], s60 offen offset:1024 lds
    s_add_u32 s60, s60, 2048
    s_waitcnt lgkmcnt(2)
    v_mfma_f32_32x32x16_bf16 v[32:47], v[112:115], a[20:23], v[32:47]
    s_waitcnt vmcnt(8)
    s_barrier
    ds_read_b128 v[96:99], v7 offset:49152
    s_add_u32 s49, s56, s49
    v_mfma_f32_32x32x16_bf16 v[48:63], v[116:119], a[20:23], v[48:63]
    s_add_u32 m0, s59, 98304
    ds_read_b128 v[100:103], v7 offset:50176
    buffer_load_dwordx4 v4, s[40:43], s60 offen lds
    s_waitcnt lgkmcnt(2)
    v_mfma_f32_32x32x16_bf16 v[64:79], v[120:123], a[20:23], v[64:79]
    ds_read_b128 v[104:107], v8 offset:49152
    s_lshl_b32 s57, s75, 1
    v_mfma_f32_32x32x16_bf16 v[80:95], v[124:127], a[20:23], v[80:95]
    s_add_u32 m0, s59, 101376
    ds_read_b128 v[108:111], v8 offset:50176
    buffer_load_dwordx4 v4, s[40:43], s60 offen offset:1024 lds
    s_waitcnt lgkmcnt(2)
    v_mfma_f32_32x32x16_bf16 v[32:47], v[96:99], a[24:27], v[32:47]
    ds_read_b128 v[112:115], v7 offset:53248
    s_add_u32 s56, s57, s54
    v_mfma_f32_32x32x16_bf16 v[48:63], v[100:103], a[24:27], v[48:63]
    s_add_u32 m0, s59, 106496
    ds_read_b128 v[116:119], v7 offset:54272
    buffer_load_dwordx4 v13, s[40:43], s60 offen lds
    s_waitcnt lgkmcnt(2)
    v_mfma_f32_32x32x16_bf16 v[64:79], v[104:107], a[24:27], v[64:79]
    ds_read_b128 v[120:123], v8 offset:53248
    s_xor_b32 s82, s54, 1
    v_mfma_f32_32x32x16_bf16 v[80:95], v[108:111], a[24:27], v[80:95]
    s_add_u32 m0, s59, 109568
    ds_read_b128 v[124:127], v8 offset:54272
    buffer_load_dwordx4 v13, s[40:43], s60 offen offset:1024 lds
    s_add_u32 s60, s60, 2048
    s_waitcnt lgkmcnt(2)
    v_mfma_f32_32x32x16_bf16 v[32:47], v[112:115], a[28:31], v[32:47]
    s_waitcnt vmcnt(8)
    s_barrier
    ds_read_b128 v[96:99], v11 offset:0
    s_add_u32 s57, s57, s82
    v_mfma_f32_32x32x16_bf16 v[48:63], v[116:119], a[28:31], v[48:63]
    s_add_u32 m0, s59, 0
    ds_read_b128 v[100:103], v11 offset:1024
    buffer_load_dwordx4 v4, s[40:43], s60 offen lds
    s_waitcnt lgkmcnt(2)
    v_mfma_f32_32x32x16_bf16 v[64:79], v[120:123], a[28:31], v[64:79]
    ds_read_b128 v[104:107], v12 offset:0
    s_mul_i32 s48, s48, 57344
    v_mfma_f32_32x32x16_bf16 v[80:95], v[124:127], a[28:31], v[80:95]
    s_add_u32 m0, s59, 3072
    ds_read_b128 v[108:111], v12 offset:1024
    buffer_load_dwordx4 v4, s[40:43], s60 offen offset:1024 lds
    s_waitcnt lgkmcnt(2)
    v_mfma_f32_32x32x16_bf16 v[32:47], v[96:99], a[32:35], v[32:47]
    ds_read_b128 v[112:115], v11 offset:4096
    s_add_u32 s48, s48, s55
    v_mfma_f32_32x32x16_bf16 v[48:63], v[100:103], a[32:35], v[48:63]
    s_add_u32 m0, s59, 8192
    ds_read_b128 v[116:119], v11 offset:5120
    buffer_load_dwordx4 v13, s[40:43], s60 offen lds
    s_waitcnt lgkmcnt(2)
    v_mfma_f32_32x32x16_bf16 v[64:79], v[104:107], a[32:35], v[64:79]
    ds_read_b128 v[120:123], v12 offset:4096
    s_mul_i32 s49, s49, 57344
    v_mfma_f32_32x32x16_bf16 v[80:95], v[108:111], a[32:35], v[80:95]
    s_add_u32 m0, s59, 11264
    ds_read_b128 v[124:127], v12 offset:5120
    buffer_load_dwordx4 v13, s[40:43], s60 offen offset:1024 lds
    s_add_u32 s60, s60, 2048
    s_waitcnt lgkmcnt(2)
    v_mfma_f32_32x32x16_bf16 v[32:47], v[112:115], a[36:39], v[32:47]
    s_waitcnt vmcnt(8)
    s_barrier
    ds_read_b128 v[96:99], v11 offset:16384
    s_add_u32 s49, s49, s55
    v_mfma_f32_32x32x16_bf16 v[48:63], v[116:119], a[36:39], v[48:63]
    s_add_u32 m0, s59, 16384
    ds_read_b128 v[100:103], v11 offset:17408
    buffer_load_dwordx4 v4, s[40:43], s60 offen lds
    s_waitcnt lgkmcnt(2)
    v_mfma_f32_32x32x16_bf16 v[64:79], v[120:123], a[36:39], v[64:79]
    ds_read_b128 v[104:107], v12 offset:16384
    s_mul_i32 s56, s56, 57344
    v_mfma_f32_32x32x16_bf16 v[80:95], v[124:127], a[36:39], v[80:95]
    s_add_u32 m0, s59, 19456
    ds_read_b128 v[108:111], v12 offset:17408
    buffer_load_dwordx4 v4, s[40:43], s60 offen offset:1024 lds
    s_waitcnt lgkmcnt(2)
    v_mfma_f32_32x32x16_bf16 v[32:47], v[96:99], a[40:43], v[32:47]
    ds_read_b128 v[112:115], v11 offset:20480
    s_add_u32 s56, s56, s55
    v_mfma_f32_32x32x16_bf16 v[48:63], v[100:103], a[40:43], v[48:63]
    s_add_u32 m0, s59, 24576
    ds_read_b128 v[116:119], v11 offset:21504
    buffer_load_dwordx4 v13, s[40:43], s60 offen lds
    s_waitcnt lgkmcnt(2)
    v_mfma_f32_32x32x16_bf16 v[64:79], v[104:107], a[40:43], v[64:79]
    ds_read_b128 v[120:123], v12 offset:20480
    s_mul_i32 s57, s57, 57344
    v_mfma_f32_32x32x16_bf16 v[80:95], v[108:111], a[40:43], v[80:95]
    s_add_u32 m0, s59, 27648
    ds_read_b128 v[124:127], v12 offset:21504
    buffer_load_dwordx4 v13, s[40:43], s60 offen offset:1024 lds
    s_add_u32 s60, s60, 2048
    s_waitcnt lgkmcnt(2)
    v_mfma_f32_32x32x16_bf16 v[32:47], v[112:115], a[44:47], v[32:47]
    s_waitcnt vmcnt(8)
    s_barrier
    ds_read_b128 v[96:99], v11 offset:32768
    s_add_u32 s57, s57, s55
    v_mfma_f32_32x32x16_bf16 v[48:63], v[116:119], a[44:47], v[48:63]
    s_add_u32 m0, s59, 32768
    ds_read_b128 v[100:103], v11 offset:33792
    buffer_load_dwordx4 v4, s[40:43], s60 offen lds
    s_waitcnt lgkmcnt(2)
    v_mfma_f32_32x32x16_bf16 v[64:79], v[120:123], a[44:47], v[64:79]
    ds_read_b128 v[104:107], v12 offset:32768
    s_add_u32 s24, s12, 10485760
    v_mfma_f32_32x32x16_bf16 v[80:95], v[124:127], a[44:47], v[80:95]
    s_add_u32 m0, s59, 35840
    ds_read_b128 v[108:111], v12 offset:33792
    buffer_load_dwordx4 v4, s[40:43], s60 offen offset:1024 lds
    s_waitcnt lgkmcnt(2)
    v_mfma_f32_32x32x16_bf16 v[32:47], v[96:99], a[48:51], v[32:47]
    ds_read_b128 v[112:115], v11 offset:36864
    s_addc_u32 s25, s13, 0
    v_mfma_f32_32x32x16_bf16 v[48:63], v[100:103], a[48:51], v[48:63]
    s_add_u32 m0, s59, 40960
    ds_read_b128 v[116:119], v11 offset:37888
    buffer_load_dwordx4 v13, s[40:43], s60 offen lds
    s_waitcnt lgkmcnt(2)
    v_mfma_f32_32x32x16_bf16 v[64:79], v[104:107], a[48:51], v[64:79]
    ds_read_b128 v[120:123], v12 offset:36864
    s_mov_b32 s26, 917504
    v_mfma_f32_32x32x16_bf16 v[80:95], v[108:111], a[48:51], v[80:95]
    s_add_u32 m0, s59, 44032
    ds_read_b128 v[124:127], v12 offset:37888
    buffer_load_dwordx4 v13, s[40:43], s60 offen offset:1024 lds
    s_add_u32 s60, s60, 2048
    s_waitcnt lgkmcnt(2)
    v_mfma_f32_32x32x16_bf16 v[32:47], v[112:115], a[52:55], v[32:47]
    s_waitcnt vmcnt(8)
    s_barrier
    ds_read_b128 v[96:99], v7 offset:0
    s_mov_b32 s27, 0x00020000
    v_mfma_f32_32x32x16_bf16 v[48:63], v[116:119], a[52:55], v[48:63]
    s_add_u32 m0, s59, 49152
    ds_read_b128 v[100:103], v7 offset:1024
    buffer_load_dwordx4 v4, s[40:43], s60 offen lds
    s_waitcnt lgkmcnt(2)
    v_mfma_f32_32x32x16_bf16 v[64:79], v[120:123], a[52:55], v[64:79]
    ds_read_b128 v[104:107], v8 offset:0
    s_mul_i32 s80, s76, 270336
    v_mfma_f32_32x32x16_bf16 v[80:95], v[124:127], a[52:55], v[80:95]
    s_add_u32 m0, s59, 52224
    ds_read_b128 v[108:111], v8 offset:1024
    buffer_load_dwordx4 v4, s[40:43], s60 offen offset:1024 lds
    s_waitcnt lgkmcnt(2)
    v_mfma_f32_32x32x16_bf16 v[32:47], v[96:99], a[56:59], v[32:47]
    ds_read_b128 v[112:115], v7 offset:4096
    s_lshl_b32 s81, s75, 7
    v_mfma_f32_32x32x16_bf16 v[48:63], v[100:103], a[56:59], v[48:63]
    s_add_u32 m0, s59, 57344
    ds_read_b128 v[116:119], v7 offset:5120
    buffer_load_dwordx4 v13, s[40:43], s60 offen lds
    s_waitcnt lgkmcnt(2)
    v_mfma_f32_32x32x16_bf16 v[64:79], v[104:107], a[56:59], v[64:79]
    ds_read_b128 v[120:123], v8 offset:4096
    s_add_u32 s80, s80, s81
    v_mfma_f32_32x32x16_bf16 v[80:95], v[108:111], a[56:59], v[80:95]
    s_add_u32 m0, s59, 60416
    ds_read_b128 v[124:127], v8 offset:5120
    buffer_load_dwordx4 v13, s[40:43], s60 offen offset:1024 lds
    s_add_u32 s60, s60, 2048
    s_waitcnt lgkmcnt(2)
    v_mfma_f32_32x32x16_bf16 v[32:47], v[112:115], a[60:63], v[32:47]
    s_waitcnt vmcnt(8)
    s_barrier
    ds_read_b128 v[96:99], v7 offset:16384
    s_add_u32 s20, s12, 19922944
    v_mfma_f32_32x32x16_bf16 v[48:63], v[116:119], a[60:63], v[48:63]
    s_add_u32 m0, s59, 65536
    ds_read_b128 v[100:103], v7 offset:17408
    buffer_load_dwordx4 v4, s[40:43], s60 offen lds
    s_waitcnt lgkmcnt(2)
    v_mfma_f32_32x32x16_bf16 v[64:79], v[120:123], a[60:63], v[64:79]
    ds_read_b128 v[104:107], v8 offset:16384
    s_addc_u32 s21, s13, 0
    v_mfma_f32_32x32x16_bf16 v[80:95], v[124:127], a[60:63], v[80:95]
    s_add_u32 m0, s59, 68608
    ds_read_b128 v[108:111], v8 offset:17408
    buffer_load_dwordx4 v4, s[40:43], s60 offen offset:1024 lds
    s_waitcnt lgkmcnt(2)
    v_mfma_f32_32x32x16_bf16 v[32:47], v[96:99], a[64:67], v[32:47]
    ds_read_b128 v[112:115], v7 offset:20480
    s_mov_b32 s22, 3670016
    v_mfma_f32_32x32x16_bf16 v[48:63], v[100:103], a[64:67], v[48:63]
    s_add_u32 m0, s59, 73728
    ds_read_b128 v[116:119], v7 offset:21504
    buffer_load_dwordx4 v13, s[40:43], s60 offen lds
    s_waitcnt lgkmcnt(2)
    v_mfma_f32_32x32x16_bf16 v[64:79], v[104:107], a[64:67], v[64:79]
    ds_read_b128 v[120:123], v8 offset:20480
    s_mov_b32 s23, 0x00020000
    v_mfma_f32_32x32x16_bf16 v[80:95], v[108:111], a[64:67], v[80:95]
    s_add_u32 m0, s59, 76800
    ds_read_b128 v[124:127], v8 offset:21504
    buffer_load_dwordx4 v13, s[40:43], s60 offen offset:1024 lds
    s_add_u32 s60, s60, 2048
    s_waitcnt lgkmcnt(2)
    v_mfma_f32_32x32x16_bf16 v[32:47], v[112:115], a[68:71], v[32:47]
    s_waitcnt vmcnt(8)
    s_barrier
    ds_read_b128 v[96:99], v7 offset:32768
    s_add_u32 s16, s12, 5242880
    v_mfma_f32_32x32x16_bf16 v[48:63], v[116:119], a[68:71], v[48:63]
    s_add_u32 m0, s59, 81920
    ds_read_b128 v[100:103], v7 offset:33792
    buffer_load_dwordx4 v4, s[40:43], s60 offen lds
    s_waitcnt lgkmcnt(2)
    v_mfma_f32_32x32x16_bf16 v[64:79], v[120:123], a[68:71], v[64:79]
    ds_read_b128 v[104:107], v8 offset:32768
    s_addc_u32 s17, s13, 0
    v_mfma_f32_32x32x16_bf16 v[80:95], v[124:127], a[68:71], v[80:95]
    s_add_u32 m0, s59, 84992
    ds_read_b128 v[108:111], v8 offset:33792
    buffer_load_dwordx4 v4, s[40:43], s60 offen offset:1024 lds
    s_waitcnt lgkmcnt(2)
    v_mfma_f32_32x32x16_bf16 v[32:47], v[96:99], a[72:75], v[32:47]
    ds_read_b128 v[112:115], v7 offset:36864
    s_add_u32 s16, s16, s80
    v_mfma_f32_32x32x16_bf16 v[48:63], v[100:103], a[72:75], v[48:63]
    s_add_u32 m0, s59, 90112
    ds_read_b128 v[116:119], v7 offset:37888
    buffer_load_dwordx4 v13, s[40:43], s60 offen lds
    s_waitcnt lgkmcnt(2)
    v_mfma_f32_32x32x16_bf16 v[64:79], v[104:107], a[72:75], v[64:79]
    ds_read_b128 v[120:123], v8 offset:36864
    s_addc_u32 s17, s17, 0
    v_mfma_f32_32x32x16_bf16 v[80:95], v[108:111], a[72:75], v[80:95]
    s_add_u32 m0, s59, 93184
    ds_read_b128 v[124:127], v8 offset:37888
    buffer_load_dwordx4 v13, s[40:43], s60 offen offset:1024 lds
    s_add_u32 s60, s60, 2048
    s_waitcnt lgkmcnt(2)
    v_mfma_f32_32x32x16_bf16 v[32:47], v[112:115], a[76:79], v[32:47]
    s_waitcnt vmcnt(8)
    s_barrier
    ds_read_b128 v[96:99], v7 offset:49152
    s_mov_b32 s18, 266240
    v_mfma_f32_32x32x16_bf16 v[48:63], v[116:119], a[76:79], v[48:63]
    s_add_u32 m0, s59, 98304
    ds_read_b128 v[100:103], v7 offset:50176
    buffer_load_dwordx4 v4, s[40:43], s60 offen lds
    s_waitcnt lgkmcnt(2)
    v_mfma_f32_32x32x16_bf16 v[64:79], v[120:123], a[76:79], v[64:79]
    ds_read_b128 v[104:107], v8 offset:49152
    s_mov_b32 s19, 0x00020000
    v_mfma_f32_32x32x16_bf16 v[80:95], v[124:127], a[76:79], v[80:95]
    s_add_u32 m0, s59, 101376
    ds_read_b128 v[108:111], v8 offset:50176
    buffer_load_dwordx4 v4, s[40:43], s60 offen offset:1024 lds
    s_waitcnt lgkmcnt(2)
    v_mfma_f32_32x32x16_bf16 v[32:47], v[96:99], a[80:83], v[32:47]
    ds_read_b128 v[112:115], v7 offset:53248
    s_mov_b32 s28, s8
    v_mfma_f32_32x32x16_bf16 v[48:63], v[100:103], a[80:83], v[48:63]
    s_add_u32 m0, s59, 106496
    ds_read_b128 v[116:119], v7 offset:54272
    buffer_load_dwordx4 v13, s[40:43], s60 offen lds
    s_waitcnt lgkmcnt(2)
    v_mfma_f32_32x32x16_bf16 v[64:79], v[104:107], a[80:83], v[64:79]
    ds_read_b128 v[120:123], v8 offset:53248
    s_mov_b32 s29, s9
    v_mfma_f32_32x32x16_bf16 v[80:95], v[108:111], a[80:83], v[80:95]
    s_add_u32 m0, s59, 109568
    ds_read_b128 v[124:127], v8 offset:54272
    buffer_load_dwordx4 v13, s[40:43], s60 offen offset:1024 lds
    s_add_u32 s60, s60, 2048
    s_waitcnt lgkmcnt(2)
    v_mfma_f32_32x32x16_bf16 v[32:47], v[112:115], a[84:87], v[32:47]
    s_waitcnt vmcnt(8)
    s_barrier
    ds_read_b128 v[96:99], v11 offset:0
    s_mov_b32 s30, 2097152
    v_mfma_f32_32x32x16_bf16 v[48:63], v[116:119], a[84:87], v[48:63]
    s_add_u32 m0, s59, 0
    ds_read_b128 v[100:103], v11 offset:1024
    buffer_load_dwordx4 v4, s[40:43], s60 offen lds
    s_waitcnt lgkmcnt(2)
    v_mfma_f32_32x32x16_bf16 v[64:79], v[120:123], a[84:87], v[64:79]
    ds_read_b128 v[104:107], v12 offset:0
    s_mov_b32 s31, 0x00020000
    v_mfma_f32_32x32x16_bf16 v[80:95], v[124:127], a[84:87], v[80:95]
    s_add_u32 m0, s59, 3072
    ds_read_b128 v[108:111], v12 offset:1024
    buffer_load_dwordx4 v4, s[40:43], s60 offen offset:1024 lds
    s_waitcnt lgkmcnt(2)
    v_mfma_f32_32x32x16_bf16 v[32:47], v[96:99], a[88:91], v[32:47]
    ds_read_b128 v[112:115], v11 offset:4096
    v_lshrrev_b32 v249, 3, v2
    v_mfma_f32_32x32x16_bf16 v[48:63], v[100:103], a[88:91], v[48:63]
    s_add_u32 m0, s59, 8192
    ds_read_b128 v[116:119], v11 offset:5120
    buffer_load_dwordx4 v13, s[40:43], s60 offen lds
    s_waitcnt lgkmcnt(2)
    v_mfma_f32_32x32x16_bf16 v[64:79], v[104:107], a[88:91], v[64:79]
    ds_read_b128 v[120:123], v12 offset:4096
    v_mul_u32_u24 v249, 4224, v249
    v_mfma_f32_32x32x16_bf16 v[80:95], v[108:111], a[88:91], v[80:95]
    s_add_u32 m0, s59, 11264
    ds_read_b128 v[124:127], v12 offset:5120
    buffer_load_dwordx4 v13, s[40:43], s60 offen offset:1024 lds
    s_add_u32 s60, s60, 2048
    s_waitcnt lgkmcnt(2)
    v_mfma_f32_32x32x16_bf16 v[32:47], v[112:115], a[92:95], v[32:47]
    s_waitcnt vmcnt(8)
    s_barrier
    ds_read_b128 v[96:99], v11 offset:16384
    v_and_b32 v250, 7, v2
    v_mfma_f32_32x32x16_bf16 v[48:63], v[116:119], a[92:95], v[48:63]
    s_add_u32 m0, s59, 16384
    ds_read_b128 v[100:103], v11 offset:17408
    buffer_load_dwordx4 v4, s[40:43], s60 offen lds
    s_waitcnt lgkmcnt(2)
    v_mfma_f32_32x32x16_bf16 v[64:79], v[120:123], a[92:95], v[64:79]
    ds_read_b128 v[104:107], v12 offset:16384
    v_and_b32 v251, 1, v9
    v_mfma_f32_32x32x16_bf16 v[80:95], v[124:127], a[92:95], v[80:95]
    s_add_u32 m0, s59, 19456
    ds_read_b128 v[108:111], v12 offset:17408
    buffer_load_dwordx4 v4, s[40:43], s60 offen offset:1024 lds
    s_waitcnt lgkmcnt(2)
    v_mfma_f32_32x32x16_bf16 v[32:47], v[96:99], a[96:99], v[32:47]
    ds_read_b128 v[112:115], v11 offset:20480
    v_lshlrev_b32 v251, 2, v251
    v_mfma_f32_32x32x16_bf16 v[48:63], v[100:103], a[96:99], v[48:63]
    s_add_u32 m0, s59, 24576
    ds_read_b128 v[116:119], v11 offset:21504
    buffer_load_dwordx4 v13, s[40:43], s60 offen lds
    s_waitcnt lgkmcnt(2)
    v_mfma_f32_32x32x16_bf16 v[64:79], v[104:107], a[96:99], v[64:79]
    ds_read_b128 v[120:123], v12 offset:20480
    v_xor_b32 v250, v250, v251
    v_mfma_f32_32x32x16_bf16 v[80:95], v[108:111], a[96:99], v[80:95]
    s_add_u32 m0, s59, 27648
    ds_read_b128 v[124:127], v12 offset:21504
    buffer_load_dwordx4 v13, s[40:43], s60 offen offset:1024 lds
    s_add_u32 s60, s60, 2048
    s_waitcnt lgkmcnt(2)
    v_mfma_f32_32x32x16_bf16 v[32:47], v[112:115], a[100:103], v[32:47]
    s_waitcnt vmcnt(8)
    s_barrier
    ds_read_b128 v[96:99], v11 offset:32768
    v_lshlrev_b32 v250, 4, v250
    v_mfma_f32_32x32x16_bf16 v[48:63], v[116:119], a[100:103], v[48:63]
    s_add_u32 m0, s59, 32768
    ds_read_b128 v[100:103], v11 offset:33792
    buffer_load_dwordx4 v4, s[40:43], s60 offen lds
    s_waitcnt lgkmcnt(2)
    v_mfma_f32_32x32x16_bf16 v[64:79], v[120:123], a[100:103], v[64:79]
    ds_read_b128 v[104:107], v12 offset:32768
    v_add_u32 v249, v249, v250
    v_mfma_f32_32x32x16_bf16 v[80:95], v[124:127], a[100:103], v[80:95]
    s_add_u32 m0, s59, 35840
    ds_read_b128 v[108:111], v12 offset:33792
    buffer_load_dwordx4 v4, s[40:43], s60 offen offset:1024 lds
    s_waitcnt lgkmcnt(2)
    v_mfma_f32_32x32x16_bf16 v[32:47], v[96:99], a[104:107], v[32:47]
    ds_read_b128 v[112:115], v11 offset:36864
    s_mul_i32 s62, s50, 67584
    v_mfma_f32_32x32x16_bf16 v[48:63], v[100:103], a[104:107], v[48:63]
    s_add_u32 m0, s59, 40960
    ds_read_b128 v[116:119], v11 offset:37888
    buffer_load_dwordx4 v13, s[40:43], s60 offen lds
    s_waitcnt lgkmcnt(2)
    v_mfma_f32_32x32x16_bf16 v[64:79], v[104:107], a[104:107], v[64:79]
    ds_read_b128 v[120:123], v12 offset:36864
    s_lshl_b32 s63, s50, 11
    v_mfma_f32_32x32x16_bf16 v[80:95], v[108:111], a[104:107], v[80:95]
    s_add_u32 m0, s59, 44032
    ds_read_b128 v[124:127], v12 offset:37888
    buffer_load_dwordx4 v13, s[40:43], s60 offen offset:1024 lds
    s_add_u32 s60, s60, 2048
    s_waitcnt lgkmcnt(2)
    v_mfma_f32_32x32x16_bf16 v[32:47], v[112:115], a[108:111], v[32:47]
    s_waitcnt vmcnt(8)
    s_barrier
    ds_read_b128 v[96:99], v7 offset:0
    s_add_u32 s65, s62, 33792
    v_mfma_f32_32x32x16_bf16 v[48:63], v[116:119], a[108:111], v[48:63]
    s_add_u32 m0, s59, 49152
    ds_read_b128 v[100:103], v7 offset:1024
    buffer_load_dwordx4 v4, s[40:43], s60 offen lds
    s_waitcnt lgkmcnt(2)
    v_mfma_f32_32x32x16_bf16 v[64:79], v[120:123], a[108:111], v[64:79]
    ds_read_b128 v[104:107], v8 offset:0
    s_lshl_b32 s78, s50, 12
    v_mfma_f32_32x32x16_bf16 v[80:95], v[124:127], a[108:111], v[80:95]
    s_add_u32 m0, s59, 52224
    ds_read_b128 v[108:111], v8 offset:1024
    buffer_load_dwordx4 v4, s[40:43], s60 offen offset:1024 lds
    s_waitcnt lgkmcnt(2)
    v_mfma_f32_32x32x16_bf16 v[32:47], v[96:99], a[112:115], v[32:47]
    ds_read_b128 v[112:115], v7 offset:4096
    s_xor_b32 s79, s50, 1
    v_mfma_f32_32x32x16_bf16 v[48:63], v[100:103], a[112:115], v[48:63]
    s_add_u32 m0, s59, 57344
    ds_read_b128 v[116:119], v7 offset:5120
    buffer_load_dwordx4 v13, s[40:43], s60 offen lds
    s_waitcnt lgkmcnt(2)
    v_mfma_f32_32x32x16_bf16 v[64:79], v[104:107], a[112:115], v[64:79]
    ds_read_b128 v[120:123], v8 offset:4096
    s_lshl_b32 s79, s79, 14
    v_mfma_f32_32x32x16_bf16 v[80:95], v[108:111], a[112:115], v[80:95]
    s_add_u32 m0, s59, 60416
    ds_read_b128 v[124:127], v8 offset:5120
    buffer_load_dwordx4 v13, s[40:43], s60 offen offset:1024 lds
    s_add_u32 s60, s60, 2048
    s_waitcnt lgkmcnt(2)
    v_mfma_f32_32x32x16_bf16 v[32:47], v[112:115], a[116:119], v[32:47]
    s_waitcnt vmcnt(8)
    s_barrier
    ds_read_b128 v[96:99], v7 offset:16384
    s_add_u32 s79, s79, s78
    v_mfma_f32_32x32x16_bf16 v[48:63], v[116:119], a[116:119], v[48:63]
    s_add_u32 m0, s59, 65536
    ds_read_b128 v[100:103], v7 offset:17408
    buffer_load_dwordx4 v4, s[40:43], s60 offen lds
    s_waitcnt lgkmcnt(2)
    v_mfma_f32_32x32x16_bf16 v[64:79], v[120:123], a[116:119], v[64:79]
    ds_read_b128 v[104:107], v8 offset:16384
    v_add_u32 v240, s79, v4
    v_mfma_f32_32x32x16_bf16 v[80:95], v[124:127], a[116:119], v[80:95]
    s_add_u32 m0, s59, 68608
    ds_read_b128 v[108:111], v8 offset:17408
    buffer_load_dwordx4 v4, s[40:43], s60 offen offset:1024 lds
    s_waitcnt lgkmcnt(2)
    v_mfma_f32_32x32x16_bf16 v[32:47], v[96:99], a[120:123], v[32:47]
    ds_read_b128 v[112:115], v7 offset:20480
    s_xor_b32 s79, s50, 1
    v_mfma_f32_32x32x16_bf16 v[48:63], v[100:103], a[120:123], v[48:63]
    s_add_u32 m0, s59, 73728
    ds_read_b128 v[116:119], v7 offset:21504
    buffer_load_dwordx4 v13, s[40:43], s60 offen lds
    s_waitcnt lgkmcnt(2)
    v_mfma_f32_32x32x16_bf16 v[64:79], v[104:107], a[120:123], v[64:79]
    ds_read_b128 v[120:123], v8 offset:20480
    s_lshl_b32 s79, s79, 12
    v_mfma_f32_32x32x16_bf16 v[80:95], v[108:111], a[120:123], v[80:95]
    s_add_u32 m0, s59, 76800
    ds_read_b128 v[124:127], v8 offset:21504
    buffer_load_dwordx4 v13, s[40:43], s60 offen offset:1024 lds
    s_add_u32 s60, s60, 2048
    s_waitcnt lgkmcnt(2)
    v_mfma_f32_32x32x16_bf16 v[32:47], v[112:115], a[124:127], v[32:47]
    s_waitcnt vmcnt(8)
    s_barrier
    ds_read_b128 v[96:99], v7 offset:32768
    s_lshl_b32 s69, s50, 14
    v_mfma_f32_32x32x16_bf16 v[48:63], v[116:119], a[124:127], v[48:63]
    s_add_u32 m0, s59, 81920
    ds_read_b128 v[100:103], v7 offset:33792
    buffer_load_dwordx4 v4, s[40:43], s60 offen lds
    s_waitcnt lgkmcnt(2)
    v_mfma_f32_32x32x16_bf16 v[64:79], v[120:123], a[124:127], v[64:79]
    ds_read_b128 v[104:107], v8 offset:32768
    s_add_u32 s79, s79, s69
    v_mfma_f32_32x32x16_bf16 v[80:95], v[124:127], a[124:127], v[80:95]
    s_add_u32 m0, s59, 84992
    ds_read_b128 v[108:111], v8 offset:33792
    buffer_load_dwordx4 v4, s[40:43], s60 offen offset:1024 lds
    s_waitcnt lgkmcnt(2)
    v_mfma_f32_32x32x16_bf16 v[32:47], v[96:99], a[128:131], v[32:47]
    ds_read_b128 v[112:115], v7 offset:36864
    v_add_u32 v243, s79, v4
    v_mfma_f32_32x32x16_bf16 v[48:63], v[100:103], a[128:131], v[48:63]
    s_add_u32 m0, s59, 90112
    ds_read_b128 v[116:119], v7 offset:37888
    buffer_load_dwordx4 v13, s[40:43], s60 offen lds
    s_waitcnt lgkmcnt(2)
    v_mfma_f32_32x32x16_bf16 v[64:79], v[104:107], a[128:131], v[64:79]
    ds_read_b128 v[120:123], v8 offset:36864
    s_xor_b32 s79, s50, 2
    v_mfma_f32_32x32x16_bf16 v[80:95], v[108:111], a[128:131], v[80:95]
    s_add_u32 m0, s59, 93184
    ds_read_b128 v[124:127], v8 offset:37888
    buffer_load_dwordx4 v13, s[40:43], s60 offen offset:1024 lds
    s_add_u32 s60, s60, 2048
    s_waitcnt lgkmcnt(2)
    v_mfma_f32_32x32x16_bf16 v[32:47], v[112:115], a[132:135], v[32:47]
    s_waitcnt vmcnt(8)
    s_barrier
    ds_read_b128 v[96:99], v7 offset:49152
    s_lshl_b32 s79, s79, 14
    v_mfma_f32_32x32x16_bf16 v[48:63], v[116:119], a[132:135], v[48:63]
    s_add_u32 m0, s59, 98304
    ds_read_b128 v[100:103], v7 offset:50176
    buffer_load_dwordx4 v4, s[40:43], s60 offen lds
    s_waitcnt lgkmcnt(2)
    v_mfma_f32_32x32x16_bf16 v[64:79], v[120:123], a[132:135], v[64:79]
    ds_read_b128 v[104:107], v8 offset:49152
    s_add_u32 s79, s79, s78
    v_mfma_f32_32x32x16_bf16 v[80:95], v[124:127], a[132:135], v[80:95]
    s_add_u32 m0, s59, 101376
    ds_read_b128 v[108:111], v8 offset:50176
    buffer_load_dwordx4 v4, s[40:43], s60 offen offset:1024 lds
    s_waitcnt lgkmcnt(2)
    v_mfma_f32_32x32x16_bf16 v[32:47], v[96:99], a[136:139], v[32:47]
    ds_read_b128 v[112:115], v7 offset:53248
    v_add_u32 v241, s79, v4
    v_mfma_f32_32x32x16_bf16 v[48:63], v[100:103], a[136:139], v[48:63]
    s_add_u32 m0, s59, 106496
    ds_read_b128 v[116:119], v7 offset:54272
    buffer_load_dwordx4 v13, s[40:43], s60 offen lds
    s_waitcnt lgkmcnt(2)
    v_mfma_f32_32x32x16_bf16 v[64:79], v[104:107], a[136:139], v[64:79]
    ds_read_b128 v[120:123], v8 offset:53248
    s_xor_b32 s79, s50, 2
    v_mfma_f32_32x32x16_bf16 v[80:95], v[108:111], a[136:139], v[80:95]
    s_add_u32 m0, s59, 109568
    ds_read_b128 v[124:127], v8 offset:54272
    buffer_load_dwordx4 v13, s[40:43], s60 offen offset:1024 lds
    s_add_u32 s60, s60, 2048
    s_waitcnt lgkmcnt(2)
    v_mfma_f32_32x32x16_bf16 v[32:47], v[112:115], a[140:143], v[32:47]
    s_waitcnt vmcnt(8)
    s_barrier
    ds_read_b128 v[96:99], v11 offset:0
    s_lshl_b32 s79, s79, 12
    v_mfma_f32_32x32x16_bf16 v[48:63], v[116:119], a[140:143], v[48:63]
    s_add_u32 m0, s59, 0
    ds_read_b128 v[100:103], v11 offset:1024
    buffer_load_dwordx4 v4, s[40:43], s60 offen lds
    s_waitcnt lgkmcnt(2)
    v_mfma_f32_32x32x16_bf16 v[64:79], v[120:123], a[140:143], v[64:79]
    ds_read_b128 v[104:107], v12 offset:0
    s_lshl_b32 s69, s50, 14
    v_mfma_f32_32x32x16_bf16 v[80:95], v[124:127], a[140:143], v[80:95]
    s_add_u32 m0, s59, 3072
    ds_read_b128 v[108:111], v12 offset:1024
    buffer_load_dwordx4 v4, s[40:43], s60 offen offset:1024 lds
    s_waitcnt lgkmcnt(2)
    v_mfma_f32_32x32x16_bf16 v[32:47], v[96:99], a[144:147], v[32:47]
    ds_read_b128 v[112:115], v11 offset:4096
    s_add_u32 s79, s79, s69
    v_mfma_f32_32x32x16_bf16 v[48:63], v[100:103], a[144:147], v[48:63]
    s_add_u32 m0, s59, 8192
    ds_read_b128 v[116:119], v11 offset:5120
    buffer_load_dwordx4 v13, s[40:43], s60 offen lds
    s_waitcnt lgkmcnt(2)
    v_mfma_f32_32x32x16_bf16 v[64:79], v[104:107], a[144:147], v[64:79]
    ds_read_b128 v[120:123], v12 offset:4096
    v_add_u32 v244, s79, v4
    v_mfma_f32_32x32x16_bf16 v[80:95], v[108:111], a[144:147], v[80:95]
    s_add_u32 m0, s59, 11264
    ds_read_b128 v[124:127], v12 offset:5120
    buffer_load_dwordx4 v13, s[40:43], s60 offen offset:1024 lds
    s_add_u32 s60, s60, 2048
    s_waitcnt lgkmcnt(2)
    v_mfma_f32_32x32x16_bf16 v[32:47], v[112:115], a[148:151], v[32:47]
    s_waitcnt vmcnt(8)
    s_barrier
    ds_read_b128 v[96:99], v11 offset:16384
    s_xor_b32 s79, s50, 3
    v_mfma_f32_32x32x16_bf16 v[48:63], v[116:119], a[148:151], v[48:63]
    s_add_u32 m0, s59, 16384
    ds_read_b128 v[100:103], v11 offset:17408
    buffer_load_dwordx4 v4, s[40:43], s60 offen lds
    s_waitcnt lgkmcnt(2)
    v_mfma_f32_32x32x16_bf16 v[64:79], v[120:123], a[148:151], v[64:79]
    ds_read_b128 v[104:107], v12 offset:16384
    s_lshl_b32 s79, s79, 14
    v_mfma_f32_32x32x16_bf16 v[80:95], v[124:127], a[148:151], v[80:95]
    s_add_u32 m0, s59, 19456
    ds_read_b128 v[108:111], v12 offset:17408
    buffer_load_dwordx4 v4, s[40:43], s60 offen offset:1024 lds
    s_waitcnt lgkmcnt(2)
    v_mfma_f32_32x32x16_bf16 v[32:47], v[96:99], a[152:155], v[32:47]
    ds_read_b128 v[112:115], v11 offset:20480
    s_add_u32 s79, s79, s78
    v_mfma_f32_32x32x16_bf16 v[48:63], v[100:103], a[152:155], v[48:63]
    s_add_u32 m0, s59, 24576
    ds_read_b128 v[116:119], v11 offset:21504
    buffer_load_dwordx4 v13, s[40:43], s60 offen lds
    s_waitcnt lgkmcnt(2)
    v_mfma_f32_32x32x16_bf16 v[64:79], v[104:107], a[152:155], v[64:79]
    ds_read_b128 v[120:123], v12 offset:20480
    v_add_u32 v242, s79, v4
    v_mfma_f32_32x32x16_bf16 v[80:95], v[108:111], a[152:155], v[80:95]
    s_add_u32 m0, s59, 27648
    ds_read_b128 v[124:127], v12 offset:21504
    buffer_load_dwordx4 v13, s[40:43], s60 offen offset:1024 lds
    s_add_u32 s60, s60, 2048
    s_waitcnt lgkmcnt(2)
    v_mfma_f32_32x32x16_bf16 v[32:47], v[112:115], a[156:159], v[32:47]
    s_waitcnt vmcnt(8)
    s_barrier
    ds_read_b128 v[96:99], v11 offset:32768
    s_xor_b32 s79, s50, 3
    v_mfma_f32_32x32x16_bf16 v[48:63], v[116:119], a[156:159], v[48:63]
    s_add_u32 m0, s59, 32768
    ds_read_b128 v[100:103], v11 offset:33792
    buffer_load_dwordx4 v4, s[40:43], s60 offen lds
    s_waitcnt lgkmcnt(2)
    v_mfma_f32_32x32x16_bf16 v[64:79], v[120:123], a[156:159], v[64:79]
    ds_read_b128 v[104:107], v12 offset:32768
    s_lshl_b32 s79, s79, 12
    v_mfma_f32_32x32x16_bf16 v[80:95], v[124:127], a[156:159], v[80:95]
    s_add_u32 m0, s59, 35840
    ds_read_b128 v[108:111], v12 offset:33792
    buffer_load_dwordx4 v4, s[40:43], s60 offen offset:1024 lds
    s_waitcnt lgkmcnt(2)
    v_mfma_f32_32x32x16_bf16 v[32:47], v[96:99], a[160:163], v[32:47]
    ds_read_b128 v[112:115], v11 offset:36864
    s_lshl_b32 s69, s50, 14
    v_mfma_f32_32x32x16_bf16 v[48:63], v[100:103], a[160:163], v[48:63]
    s_add_u32 m0, s59, 40960
    ds_read_b128 v[116:119], v11 offset:37888
    buffer_load_dwordx4 v13, s[40:43], s60 offen lds
    s_waitcnt lgkmcnt(2)
    v_mfma_f32_32x32x16_bf16 v[64:79], v[104:107], a[160:163], v[64:79]
    ds_read_b128 v[120:123], v12 offset:36864
    s_add_u32 s79, s79, s69
    v_mfma_f32_32x32x16_bf16 v[80:95], v[108:111], a[160:163], v[80:95]
    s_add_u32 m0, s59, 44032
    ds_read_b128 v[124:127], v12 offset:37888
    buffer_load_dwordx4 v13, s[40:43], s60 offen offset:1024 lds
    s_add_u32 s60, s60, 2048
    s_waitcnt lgkmcnt(2)
    v_mfma_f32_32x32x16_bf16 v[32:47], v[112:115], a[164:167], v[32:47]
    s_waitcnt vmcnt(8)
    s_barrier
    ds_read_b128 v[96:99], v7 offset:0
    v_add_u32 v245, s79, v4
    v_mfma_f32_32x32x16_bf16 v[48:63], v[116:119], a[164:167], v[48:63]
    s_add_u32 m0, s59, 49152
    ds_read_b128 v[100:103], v7 offset:1024
    buffer_load_dwordx4 v4, s[40:43], s60 offen lds
    s_waitcnt lgkmcnt(2)
    v_mfma_f32_32x32x16_bf16 v[64:79], v[120:123], a[164:167], v[64:79]
    ds_read_b128 v[104:107], v8 offset:0
    v_lshrrev_b32 v246, 1, v9
    v_mfma_f32_32x32x16_bf16 v[80:95], v[124:127], a[164:167], v[80:95]
    s_add_u32 m0, s59, 52224
    ds_read_b128 v[108:111], v8 offset:1024
    buffer_load_dwordx4 v4, s[40:43], s60 offen offset:1024 lds
    s_waitcnt lgkmcnt(2)
    v_mfma_f32_32x32x16_bf16 v[32:47], v[96:99], a[168:171], v[32:47]
    ds_read_b128 v[112:115], v7 offset:4096
    v_lshlrev_b32 v246, 2, v246
    v_mfma_f32_32x32x16_bf16 v[48:63], v[100:103], a[168:171], v[48:63]
    s_add_u32 m0, s59, 57344
    ds_read_b128 v[116:119], v7 offset:5120
    buffer_load_dwordx4 v13, s[40:43], s60 offen lds
    s_waitcnt lgkmcnt(2)
    v_mfma_f32_32x32x16_bf16 v[64:79], v[104:107], a[168:171], v[64:79]
    ds_read_b128 v[120:123], v8 offset:4096
    v_lshrrev_b32 v247, 2, v10
    v_mfma_f32_32x32x16_bf16 v[80:95], v[108:111], a[168:171], v[80:95]
    s_add_u32 m0, s59, 60416
    ds_read_b128 v[124:127], v8 offset:5120
    buffer_load_dwordx4 v13, s[40:43], s60 offen offset:1024 lds
    s_add_u32 s60, s60, 2048
    s_waitcnt lgkmcnt(2)
    v_mfma_f32_32x32x16_bf16 v[32:47], v[112:115], a[172:175], v[32:47]
    s_waitcnt vmcnt(8)
    s_barrier
    ds_read_b128 v[96:99], v7 offset:16384
    v_add_u32 v246, v246, v247
    v_mfma_f32_32x32x16_bf16 v[48:63], v[116:119], a[172:175], v[48:63]
    s_add_u32 m0, s59, 65536
    ds_read_b128 v[100:103], v7 offset:17408
    buffer_load_dwordx4 v4, s[40:43], s60 offen lds
    s_waitcnt lgkmcnt(2)
    v_mfma_f32_32x32x16_bf16 v[64:79], v[120:123], a[172:175], v[64:79]
    ds_read_b128 v[104:107], v8 offset:16384
    s_lshl_b32 s69, s53, 5
    v_mfma_f32_32x32x16_bf16 v[80:95], v[124:127], a[172:175], v[80:95]
    s_add_u32 m0, s59, 68608
    ds_read_b128 v[108:111], v8 offset:17408
    buffer_load_dwordx4 v4, s[40:43], s60 offen offset:1024 lds
    s_waitcnt lgkmcnt(2)
    v_mfma_f32_32x32x16_bf16 v[32:47], v[96:99], a[176:179], v[32:47]
    ds_read_b128 v[112:115], v7 offset:20480
    v_add_u32 v246, s69, v246
    v_mfma_f32_32x32x16_bf16 v[48:63], v[100:103], a[176:179], v[48:63]
    s_add_u32 m0, s59, 73728
    ds_read_b128 v[116:119], v7 offset:21504
    buffer_load_dwordx4 v13, s[40:43], s60 offen lds
    s_waitcnt lgkmcnt(2)
    v_mfma_f32_32x32x16_bf16 v[64:79], v[104:107], a[176:179], v[64:79]
    ds_read_b128 v[120:123], v8 offset:20480
    v_lshlrev_b32 v246, 7, v246
    v_mfma_f32_32x32x16_bf16 v[80:95], v[108:111], a[176:179], v[80:95]
    s_add_u32 m0, s59, 76800
    ds_read_b128 v[124:127], v8 offset:21504
    buffer_load_dwordx4 v13, s[40:43], s60 offen offset:1024 lds
    s_add_u32 s60, s60, 2048
    s_waitcnt lgkmcnt(2)
    v_mfma_f32_32x32x16_bf16 v[32:47], v[112:115], a[180:183], v[32:47]
    s_waitcnt vmcnt(8)
    s_barrier
    ds_read_b128 v[96:99], v7 offset:32768
    v_and_b32 v247, 1, v9
    v_mfma_f32_32x32x16_bf16 v[48:63], v[116:119], a[180:183], v[48:63]
    s_add_u32 m0, s59, 81920
    ds_read_b128 v[100:103], v7 offset:33792
    buffer_load_dwordx4 v4, s[40:43], s60 offen lds
    s_waitcnt lgkmcnt(2)
    v_mfma_f32_32x32x16_bf16 v[64:79], v[120:123], a[180:183], v[64:79]
    ds_read_b128 v[104:107], v8 offset:32768
    v_lshlrev_b32 v247, 5, v247
    v_mfma_f32_32x32x16_bf16 v[80:95], v[124:127], a[180:183], v[80:95]
    s_add_u32 m0, s59, 84992
    ds_read_b128 v[108:111], v8 offset:33792
    buffer_load_dwordx4 v4, s[40:43], s60 offen offset:1024 lds
    s_waitcnt lgkmcnt(2)
    v_mfma_f32_32x32x16_bf16 v[32:47], v[96:99], a[184:187], v[32:47]
    ds_read_b128 v[112:115], v7 offset:36864
    v_and_b32 v248, 3, v10
    v_mfma_f32_32x32x16_bf16 v[48:63], v[100:103], a[184:187], v[48:63]
    s_add_u32 m0, s59, 90112
    ds_read_b128 v[116:119], v7 offset:37888
    buffer_load_dwordx4 v13, s[40:43], s60 offen lds
    s_waitcnt lgkmcnt(2)
    v_mfma_f32_32x32x16_bf16 v[64:79], v[104:107], a[184:187], v[64:79]
    ds_read_b128 v[120:123], v8 offset:36864
    v_lshlrev_b32 v248, 3, v248
    v_mfma_f32_32x32x16_bf16 v[80:95], v[108:111], a[184:187], v[80:95]
    s_add_u32 m0, s59, 93184
    ds_read_b128 v[124:127], v8 offset:37888
    buffer_load_dwordx4 v13, s[40:43], s60 offen offset:1024 lds
    s_add_u32 s60, s60, 2048
    s_waitcnt lgkmcnt(2)
    v_mfma_f32_32x32x16_bf16 v[32:47], v[112:115], a[188:191], v[32:47]
    s_waitcnt vmcnt(8)
    s_barrier
    ds_read_b128 v[96:99], v7 offset:49152
    v_add3_u32 v246, v246, v247, v248
    v_mfma_f32_32x32x16_bf16 v[48:63], v[116:119], a[188:191], v[48:63]
    s_add_u32 m0, s59, 98304
    ds_read_b128 v[100:103], v7 offset:50176
    buffer_load_dwordx4 v4, s[40:43], s60 offen lds
    s_waitcnt lgkmcnt(2)
    v_mfma_f32_32x32x16_bf16 v[64:79], v[120:123], a[188:191], v[64:79]
    ds_read_b128 v[104:107], v8 offset:49152
    v_lshrrev_b32 v247, 3, v10
    v_mfma_f32_32x32x16_bf16 v[80:95], v[124:127], a[188:191], v[80:95]
    s_add_u32 m0, s59, 101376
    ds_read_b128 v[108:111], v8 offset:50176
    buffer_load_dwordx4 v4, s[40:43], s60 offen offset:1024 lds
    s_waitcnt lgkmcnt(2)
    v_mfma_f32_32x32x16_bf16 v[32:47], v[96:99], a[192:195], v[32:47]
    ds_read_b128 v[112:115], v7 offset:53248
    v_xor_b32 v247, s54, v247
    v_mfma_f32_32x32x16_bf16 v[48:63], v[100:103], a[192:195], v[48:63]
    s_add_u32 m0, s59, 106496
    ds_read_b128 v[116:119], v7 offset:54272
    buffer_load_dwordx4 v13, s[40:43], s60 offen lds
    s_waitcnt lgkmcnt(2)
    v_mfma_f32_32x32x16_bf16 v[64:79], v[104:107], a[192:195], v[64:79]
    ds_read_b128 v[120:123], v8 offset:53248
    v_lshlrev_b32 v247, 6, v247
    v_mfma_f32_32x32x16_bf16 v[80:95], v[108:111], a[192:195], v[80:95]
    s_add_u32 m0, s59, 109568
    ds_read_b128 v[124:127], v8 offset:54272
    buffer_load_dwordx4 v13, s[40:43], s60 offen offset:1024 lds
    s_add_u32 s60, s60, 2048
    s_waitcnt lgkmcnt(2)
    v_mfma_f32_32x32x16_bf16 v[32:47], v[112:115], a[196:199], v[32:47]
    s_waitcnt vmcnt(8)
    s_barrier
    ds_read_b128 v[96:99], v11 offset:0
    v_add_u32 v246, v246, v247
    v_mfma_f32_32x32x16_bf16 v[48:63], v[116:119], a[196:199], v[48:63]
    s_add_u32 m0, s59, 0
    ds_read_b128 v[100:103], v11 offset:1024
    buffer_load_dwordx4 v4, s[40:43], s60 offen lds
    s_waitcnt lgkmcnt(2)
    v_mfma_f32_32x32x16_bf16 v[64:79], v[120:123], a[196:199], v[64:79]
    ds_read_b128 v[104:107], v12 offset:0
    v_add_u32 v246, 151552, v246
    v_mfma_f32_32x32x16_bf16 v[80:95], v[124:127], a[196:199], v[80:95]
    s_add_u32 m0, s59, 3072
    ds_read_b128 v[108:111], v12 offset:1024
    buffer_load_dwordx4 v4, s[40:43], s60 offen offset:1024 lds
    s_waitcnt lgkmcnt(2)
    v_mfma_f32_32x32x16_bf16 v[32:47], v[96:99], a[200:203], v[32:47]
    ds_read_b128 v[112:115], v11 offset:4096
    s_lshl_b32 s69, s75, 6
    v_mfma_f32_32x32x16_bf16 v[48:63], v[100:103], a[200:203], v[48:63]
    s_add_u32 m0, s59, 8192
    ds_read_b128 v[116:119], v11 offset:5120
    buffer_load_dwordx4 v13, s[40:43], s60 offen lds
    s_waitcnt lgkmcnt(2)
    v_mfma_f32_32x32x16_bf16 v[64:79], v[104:107], a[200:203], v[64:79]
    ds_read_b128 v[120:123], v12 offset:4096
    s_lshl_b32 s80, s54, 5
    v_mfma_f32_32x32x16_bf16 v[80:95], v[108:111], a[200:203], v[80:95]
    s_add_u32 m0, s59, 11264
    ds_read_b128 v[124:127], v12 offset:5120
    buffer_load_dwordx4 v13, s[40:43], s60 offen offset:1024 lds
    s_add_u32 s60, s60, 2048
    s_waitcnt lgkmcnt(2)
    v_mfma_f32_32x32x16_bf16 v[32:47], v[112:115], a[204:207], v[32:47]
    s_waitcnt vmcnt(8)
    s_barrier
    ds_read_b128 v[96:99], v11 offset:16384
    s_add_u32 s69, s69, s80
    v_mfma_f32_32x32x16_bf16 v[48:63], v[116:119], a[204:207], v[48:63]
    s_add_u32 m0, s59, 16384
    ds_read_b128 v[100:103], v11 offset:17408
    buffer_load_dwordx4 v4, s[40:43], s60 offen lds
    s_waitcnt lgkmcnt(2)
    v_mfma_f32_32x32x16_bf16 v[64:79], v[120:123], a[204:207], v[64:79]
    ds_read_b128 v[104:107], v12 offset:16384
    v_add_u32 v247, s69, v5
    v_mfma_f32_32x32x16_bf16 v[80:95], v[124:127], a[204:207], v[80:95]
    s_add_u32 m0, s59, 19456
    ds_read_b128 v[108:111], v12 offset:17408
    buffer_load_dwordx4 v4, s[40:43], s60 offen offset:1024 lds
    s_waitcnt lgkmcnt(2)
    v_mfma_f32_32x32x16_bf16 v[32:47], v[96:99], a[208:211], v[32:47]
    ds_read_b128 v[112:115], v11 offset:20480
    v_lshlrev_b32 v247, 10, v247
    v_mfma_f32_32x32x16_bf16 v[48:63], v[100:103], a[208:211], v[48:63]
    s_add_u32 m0, s59, 24576
    ds_read_b128 v[116:119], v11 offset:21504
    buffer_load_dwordx4 v13, s[40:43], s60 offen lds
    s_waitcnt lgkmcnt(2)
    v_mfma_f32_32x32x16_bf16 v[64:79], v[104:107], a[208:211], v[64:79]
    ds_read_b128 v[120:123], v12 offset:20480
    v_lshlrev_b32 v248, 4, v6
    v_mfma_f32_32x32x16_bf16 v[80:95], v[108:111], a[208:211], v[80:95]
    s_add_u32 m0, s59, 27648
    ds_read_b128 v[124:127], v12 offset:21504
    buffer_load_dwordx4 v13, s[40:43], s60 offen offset:1024 lds
    s_add_u32 s60, s60, 2048
    s_waitcnt lgkmcnt(2)
    v_mfma_f32_32x32x16_bf16 v[32:47], v[112:115], a[212:215], v[32:47]
    s_waitcnt vmcnt(8)
    s_barrier
    ds_read_b128 v[96:99], v11 offset:32768
    s_lshl_b32 s69, s76, 7
    v_mfma_f32_32x32x16_bf16 v[48:63], v[116:119], a[212:215], v[48:63]
    s_add_u32 m0, s59, 32768
    ds_read_b128 v[100:103], v11 offset:33792
    buffer_load_dwordx4 v4, s[40:43], s60 offen lds
    s_waitcnt lgkmcnt(2)
    v_mfma_f32_32x32x16_bf16 v[64:79], v[120:123], a[212:215], v[64:79]
    ds_read_b128 v[104:107], v12 offset:32768
    s_lshl_b32 s80, s53, 6
    v_mfma_f32_32x32x16_bf16 v[80:95], v[124:127], a[212:215], v[80:95]
    s_add_u32 m0, s59, 35840
    ds_read_b128 v[108:111], v12 offset:33792
    buffer_load_dwordx4 v4, s[40:43], s60 offen offset:1024 lds
    s_waitcnt lgkmcnt(2)
    v_mfma_f32_32x32x16_bf16 v[32:47], v[96:99], a[216:219], v[32:47]
    ds_read_b128 v[112:115], v11 offset:36864
    s_add_u32 s69, s69, s80
    v_mfma_f32_32x32x16_bf16 v[48:63], v[100:103], a[216:219], v[48:63]
    s_add_u32 m0, s59, 40960
    ds_read_b128 v[116:119], v11 offset:37888
    buffer_load_dwordx4 v13, s[40:43], s60 offen lds
    s_waitcnt lgkmcnt(2)
    v_mfma_f32_32x32x16_bf16 v[64:79], v[104:107], a[216:219], v[64:79]
    ds_read_b128 v[120:123], v12 offset:36864
    v_add3_u32 v247, v247, v248, s69
    v_mfma_f32_32x32x16_bf16 v[80:95], v[108:111], a[216:219], v[80:95]
    s_add_u32 m0, s59, 44032
    ds_read_b128 v[124:127], v12 offset:37888
    buffer_load_dwordx4 v13, s[40:43], s60 offen offset:1024 lds
    s_add_u32 s60, s60, 2048
    s_waitcnt lgkmcnt(2)
    v_mfma_f32_32x32x16_bf16 v[32:47], v[112:115], a[220:223], v[32:47]
    s_waitcnt vmcnt(8)
    s_barrier
    ds_read_b128 v[96:99], v7 offset:0
    v_mfma_f32_32x32x16_bf16 v[48:63], v[116:119], a[220:223], v[48:63]
    s_add_u32 m0, s59, 49152
    ds_read_b128 v[100:103], v7 offset:1024
    buffer_load_dwordx4 v4, s[40:43], s60 offen lds
    s_waitcnt lgkmcnt(2)
    v_mfma_f32_32x32x16_bf16 v[64:79], v[120:123], a[220:223], v[64:79]
    ds_read_b128 v[104:107], v8 offset:0
    v_mfma_f32_32x32x16_bf16 v[80:95], v[124:127], a[220:223], v[80:95]
    s_add_u32 m0, s59, 52224
    ds_read_b128 v[108:111], v8 offset:1024
    buffer_load_dwordx4 v4, s[40:43], s60 offen offset:1024 lds
    s_waitcnt lgkmcnt(2)
    v_mfma_f32_32x32x16_bf16 v[32:47], v[96:99], a[224:227], v[32:47]
    ds_read_b128 v[112:115], v7 offset:4096
    v_mfma_f32_32x32x16_bf16 v[48:63], v[100:103], a[224:227], v[48:63]
    s_add_u32 m0, s59, 57344
    ds_read_b128 v[116:119], v7 offset:5120
    buffer_load_dwordx4 v13, s[40:43], s60 offen lds
    s_waitcnt lgkmcnt(2)
    v_mfma_f32_32x32x16_bf16 v[64:79], v[104:107], a[224:227], v[64:79]
    ds_read_b128 v[120:123], v8 offset:4096
    v_mfma_f32_32x32x16_bf16 v[80:95], v[108:111], a[224:227], v[80:95]
    s_add_u32 m0, s59, 60416
    ds_read_b128 v[124:127], v8 offset:5120
    buffer_load_dwordx4 v13, s[40:43], s60 offen offset:1024 lds
    s_add_u32 s60, s60, 2048
    s_waitcnt lgkmcnt(2)
    v_mfma_f32_32x32x16_bf16 v[32:47], v[112:115], a[228:231], v[32:47]
    s_waitcnt vmcnt(8)
    s_barrier
    ds_read_b128 v[96:99], v7 offset:16384
    v_mfma_f32_32x32x16_bf16 v[48:63], v[116:119], a[228:231], v[48:63]
    ds_read_b128 v[100:103], v7 offset:17408
    s_waitcnt lgkmcnt(2)
    v_mfma_f32_32x32x16_bf16 v[64:79], v[120:123], a[228:231], v[64:79]
    ds_read_b128 v[104:107], v8 offset:16384
    v_mfma_f32_32x32x16_bf16 v[80:95], v[124:127], a[228:231], v[80:95]
    ds_read_b128 v[108:111], v8 offset:17408
    s_waitcnt lgkmcnt(2)
    v_mfma_f32_32x32x16_bf16 v[32:47], v[96:99], a[232:235], v[32:47]
    ds_read_b128 v[112:115], v7 offset:20480
    v_mfma_f32_32x32x16_bf16 v[48:63], v[100:103], a[232:235], v[48:63]
    ds_read_b128 v[116:119], v7 offset:21504
    s_waitcnt lgkmcnt(2)
    v_mfma_f32_32x32x16_bf16 v[64:79], v[104:107], a[232:235], v[64:79]
    ds_read_b128 v[120:123], v8 offset:20480
    v_mfma_f32_32x32x16_bf16 v[80:95], v[108:111], a[232:235], v[80:95]
    ds_read_b128 v[124:127], v8 offset:21504
    s_waitcnt lgkmcnt(2)
    v_mfma_f32_32x32x16_bf16 v[32:47], v[112:115], a[236:239], v[32:47]
    s_waitcnt vmcnt(4)
    s_barrier
    ds_read_b128 v[96:99], v7 offset:32768
    v_mfma_f32_32x32x16_bf16 v[48:63], v[116:119], a[236:239], v[48:63]
    ds_read_b128 v[100:103], v7 offset:33792
    s_waitcnt lgkmcnt(2)
    v_mfma_f32_32x32x16_bf16 v[64:79], v[120:123], a[236:239], v[64:79]
    ds_read_b128 v[104:107], v8 offset:32768
    v_mfma_f32_32x32x16_bf16 v[80:95], v[124:127], a[236:239], v[80:95]
    ds_read_b128 v[108:111], v8 offset:33792
    s_waitcnt lgkmcnt(2)
    v_mfma_f32_32x32x16_bf16 v[32:47], v[96:99], a[240:243], v[32:47]
    ds_read_b128 v[112:115], v7 offset:36864
    v_mfma_f32_32x32x16_bf16 v[48:63], v[100:103], a[240:243], v[48:63]
    ds_read_b128 v[116:119], v7 offset:37888
    s_waitcnt lgkmcnt(2)
    v_mfma_f32_32x32x16_bf16 v[64:79], v[104:107], a[240:243], v[64:79]
    ds_read_b128 v[120:123], v8 offset:36864
    v_mfma_f32_32x32x16_bf16 v[80:95], v[108:111], a[240:243], v[80:95]
    ds_read_b128 v[124:127], v8 offset:37888
    s_waitcnt lgkmcnt(2)
    v_mfma_f32_32x32x16_bf16 v[32:47], v[112:115], a[244:247], v[32:47]
    s_waitcnt vmcnt(0)
    s_barrier
    ds_read_b128 v[96:99], v7 offset:49152
    v_mfma_f32_32x32x16_bf16 v[48:63], v[116:119], a[244:247], v[48:63]
    ds_read_b128 v[100:103], v7 offset:50176
    s_waitcnt lgkmcnt(2)
    v_mfma_f32_32x32x16_bf16 v[64:79], v[120:123], a[244:247], v[64:79]
    ds_read_b128 v[104:107], v8 offset:49152
    v_mfma_f32_32x32x16_bf16 v[80:95], v[124:127], a[244:247], v[80:95]
    ds_read_b128 v[108:111], v8 offset:50176
    s_waitcnt lgkmcnt(2)
    v_mfma_f32_32x32x16_bf16 v[32:47], v[96:99], a[248:251], v[32:47]
    ds_read_b128 v[112:115], v7 offset:53248
    v_mfma_f32_32x32x16_bf16 v[48:63], v[100:103], a[248:251], v[48:63]
    ds_read_b128 v[116:119], v7 offset:54272
    s_waitcnt lgkmcnt(2)
    v_mfma_f32_32x32x16_bf16 v[64:79], v[104:107], a[248:251], v[64:79]
    ds_read_b128 v[120:123], v8 offset:53248
    v_mfma_f32_32x32x16_bf16 v[80:95], v[108:111], a[248:251], v[80:95]
    ds_read_b128 v[124:127], v8 offset:54272
    s_waitcnt lgkmcnt(2)
    v_mfma_f32_32x32x16_bf16 v[32:47], v[112:115], a[252:255], v[32:47]
    v_mfma_f32_32x32x16_bf16 v[48:63], v[116:119], a[252:255], v[48:63]
    s_waitcnt lgkmcnt(0)
    v_mfma_f32_32x32x16_bf16 v[64:79], v[120:123], a[252:255], v[64:79]
    v_mfma_f32_32x32x16_bf16 v[80:95], v[124:127], a[252:255], v[80:95]
    s_lshl_b32 s69, s50, 13
    v_add_u32 v7, s69, v4
    s_xor_b32 s69, s69, 16384
    v_add_u32 v8, s69, v4
    s_lshl_b32 s69, s64, 13
    s_lshl_b32 s80, s58, 11
    s_add_u32 s69, s69, s80
    s_add_u32 s69, s69, 135168
    v_add_u32 v11, s69, v4
    ds_read_b128 v[128:131], v11 offset:0
    ds_read_b128 v[132:135], v11 offset:1024
    ds_read_b128 v[136:139], v11 offset:4096
    ds_read_b128 v[140:143], v11 offset:5120
    s_barrier
    ds_write_b128 v7, v[64:67] offset:0
    ds_write_b128 v7, v[68:71] offset:1024
    ds_write_b128 v7, v[72:75] offset:2048
    ds_write_b128 v7, v[76:79] offset:3072
    ds_write_b128 v7, v[80:83] offset:4096
    ds_write_b128 v7, v[84:87] offset:5120
    ds_write_b128 v7, v[88:91] offset:6144
    ds_write_b128 v7, v[92:95] offset:7168
    s_waitcnt lgkmcnt(8)
    v_lshlrev_b32 v176, 16, v128
    v_and_b32 v177, 0xffff0000, v128
    v_lshlrev_b32 v178, 16, v129
    v_and_b32 v179, 0xffff0000, v129
    v_lshlrev_b32 v180, 16, v130
    v_and_b32 v181, 0xffff0000, v130
    v_lshlrev_b32 v182, 16, v131
    v_and_b32 v183, 0xffff0000, v131
    v_lshlrev_b32 v184, 16, v132
    v_and_b32 v185, 0xffff0000, v132
    v_lshlrev_b32 v186, 16, v133
    v_and_b32 v187, 0xffff0000, v133
    v_lshlrev_b32 v188, 16, v134
    v_and_b32 v189, 0xffff0000, v134
    v_lshlrev_b32 v190, 16, v135
    v_and_b32 v191, 0xffff0000, v135
    s_waitcnt lgkmcnt(0)
    s_barrier
    ds_read_b128 v[144:147], v8 offset:0
    ds_read_b128 v[148:151], v8 offset:1024
    ds_read_b128 v[152:155], v8 offset:2048
    ds_read_b128 v[156:159], v8 offset:3072
    ds_read_b128 v[160:163], v8 offset:4096
    ds_read_b128 v[164:167], v8 offset:5120
    ds_read_b128 v[168:171], v8 offset:6144
    ds_read_b128 v[172:175], v8 offset:7168
    v_lshlrev_b32 v192, 16, v136
    v_and_b32 v193, 0xffff0000, v136
    v_lshlrev_b32 v194, 16, v137
    v_and_b32 v195, 0xffff0000, v137
    v_lshlrev_b32 v196, 16, v138
    v_and_b32 v197, 0xffff0000, v138
    v_lshlrev_b32 v198, 16, v139
    v_and_b32 v199, 0xffff0000, v139
    v_lshlrev_b32 v200, 16, v140
    v_and_b32 v201, 0xffff0000, v140
    v_lshlrev_b32 v202, 16, v141
    v_and_b32 v203, 0xffff0000, v141
    v_lshlrev_b32 v204, 16, v142
    v_and_b32 v205, 0xffff0000, v142
    v_lshlrev_b32 v206, 16, v143
    v_and_b32 v207, 0xffff0000, v143
    s_lshl_b32 s69, s51, 1
    s_add_u32 s69, s69, s58
    s_mul_i32 s69, s69, 56
    s_lshl_b32 s80, s52, 3
    s_add_u32 s69, s69, s80
    s_lshl_b32 s80, s64, 2
    s_add_u32 s69, s69, s80
    s_lshl_b32 s69, s69, 10
    s_waitcnt lgkmcnt(4)
    v_pk_add_f32 v[32:33], v[32:33], v[144:145]
    v_pk_add_f32 v[34:35], v[34:35], v[146:147]
    v_pk_add_f32 v[36:37], v[36:37], v[148:149]
    v_pk_add_f32 v[38:39], v[38:39], v[150:151]
    v_pk_add_f32 v[40:41], v[40:41], v[152:153]
    v_pk_add_f32 v[42:43], v[42:43], v[154:155]
    v_pk_add_f32 v[44:45], v[44:45], v[156:157]
    v_pk_add_f32 v[46:47], v[46:47], v[158:159]
    v_pk_mul_f32 v[32:33], v[32:33], v[176:177]
    v_pk_mul_f32 v[34:35], v[34:35], v[178:179]
    v_pk_mul_f32 v[36:37], v[36:37], v[180:181]
    v_pk_mul_f32 v[38:39], v[38:39], v[182:183]
    v_pk_mul_f32 v[40:41], v[40:41], v[184:185]
    v_pk_mul_f32 v[42:43], v[42:43], v[186:187]
    v_pk_mul_f32 v[44:45], v[44:45], v[188:189]
    v_pk_mul_f32 v[46:47], v[46:47], v[190:191]
    v_cvt_pk_bf16_f32 v208, v32, v33
    v_cvt_pk_bf16_f32 v209, v34, v35
    v_cvt_pk_bf16_f32 v210, v36, v37
    v_cvt_pk_bf16_f32 v211, v38, v39
    v_cvt_pk_bf16_f32 v212, v40, v41
    v_cvt_pk_bf16_f32 v213, v42, v43
    v_cvt_pk_bf16_f32 v214, v44, v45
    v_cvt_pk_bf16_f32 v215, v46, v47
    s_waitcnt lgkmcnt(0)
    v_pk_add_f32 v[48:49], v[48:49], v[160:161]
    v_pk_add_f32 v[50:51], v[50:51], v[162:163]
    v_pk_add_f32 v[52:53], v[52:53], v[164:165]
    v_pk_add_f32 v[54:55], v[54:55], v[166:167]
    v_pk_add_f32 v[56:57], v[56:57], v[168:169]
    v_pk_add_f32 v[58:59], v[58:59], v[170:171]
    v_pk_add_f32 v[60:61], v[60:61], v[172:173]
    v_pk_add_f32 v[62:63], v[62:63], v[174:175]
    v_pk_mul_f32 v[48:49], v[48:49], v[192:193]
    v_pk_mul_f32 v[50:51], v[50:51], v[194:195]
    v_pk_mul_f32 v[52:53], v[52:53], v[196:197]
    v_pk_mul_f32 v[54:55], v[54:55], v[198:199]
    v_pk_mul_f32 v[56:57], v[56:57], v[200:201]
    v_pk_mul_f32 v[58:59], v[58:59], v[202:203]
    v_pk_mul_f32 v[60:61], v[60:61], v[204:205]
    v_pk_mul_f32 v[62:63], v[62:63], v[206:207]
    v_cvt_pk_bf16_f32 v216, v48, v49
    v_cvt_pk_bf16_f32 v217, v50, v51
    v_cvt_pk_bf16_f32 v218, v52, v53
    v_cvt_pk_bf16_f32 v219, v54, v55
    v_cvt_pk_bf16_f32 v220, v56, v57
    v_cvt_pk_bf16_f32 v221, v58, v59
    v_cvt_pk_bf16_f32 v222, v60, v61
    v_cvt_pk_bf16_f32 v223, v62, v63
    s_nop 1
    v_permlane32_swap_b32 v208, v210
    v_permlane32_swap_b32 v209, v211
    v_permlane32_swap_b32 v212, v214
    v_permlane32_swap_b32 v213, v215
    v_permlane32_swap_b32 v216, v218
    v_permlane32_swap_b32 v217, v219
    v_permlane32_swap_b32 v220, v222
    v_permlane32_swap_b32 v221, v223
    buffer_store_dwordx4 v[208:211], v4, s[20:23], s69 offen offset:0 sc0 sc1
    buffer_store_dwordx4 v[212:215], v4, s[20:23], s69 offen offset:1024 sc0 sc1
    buffer_store_dwordx4 v[216:219], v4, s[20:23], s69 offen offset:2048 sc0 sc1
    buffer_store_dwordx4 v[220:223], v4, s[20:23], s69 offen offset:3072 sc0 sc1
    buffer_load_dwordx4 a[0:3], v4, s[24:27], s48 offen offset:0
    buffer_load_dwordx4 a[56:59], v4, s[24:27], s49 offen offset:0
    buffer_load_dwordx4 a[4:7], v4, s[24:27], s48 offen offset:1024
    buffer_load_dwordx4 a[60:63], v4, s[24:27], s49 offen offset:1024
    buffer_load_dwordx4 a[8:11], v4, s[24:27], s48 offen offset:2048
    buffer_load_dwordx4 a[64:67], v4, s[24:27], s49 offen offset:2048
    buffer_load_dwordx4 a[12:15], v4, s[24:27], s48 offen offset:3072
    buffer_load_dwordx4 a[68:71], v4, s[24:27], s49 offen offset:3072
    s_add_u32 s48, s48, 4096
    s_add_u32 s49, s49, 4096
    buffer_load_dwordx4 a[16:19], v4, s[24:27], s48 offen offset:0
    buffer_load_dwordx4 a[72:75], v4, s[24:27], s49 offen offset:0
    buffer_load_dwordx4 a[20:23], v4, s[24:27], s48 offen offset:1024
    buffer_load_dwordx4 a[76:79], v4, s[24:27], s49 offen offset:1024
    s_waitcnt vmcnt(12)
    s_barrier
    s_cmp_eq_u32 s50, 0
    s_cbranch_scc0 KB_NOFLAGD
    s_lshl_b32 s69, s51, 7
    s_lshl_b32 s80, s52, 2
    s_add_u32 s69, s69, s80
    s_add_u32 s69, s69, 4096
    v_mov_b32 v176, s69
    v_mov_b32 v177, 0x7fffffff
    v_cmp_eq_u32 vcc, 0, v2
    v_mov_b32 v178, 1
    s_nop 0
    v_cndmask_b32 v176, v177, v176, vcc
    buffer_store_dword v178, v176, s[36:39], 0 offen sc0 sc1
KB_NOFLAGD:
    buffer_load_dwordx4 a[24:27], v4, s[24:27], s48 offen offset:2048
    buffer_load_dwordx4 a[80:83], v4, s[24:27], s49 offen offset:2048
    buffer_load_dwordx4 a[28:31], v4, s[24:27], s48 offen offset:3072
    buffer_load_dwordx4 a[84:87], v4, s[24:27], s49 offen offset:3072
    s_add_u32 s48, s48, 4096
    s_add_u32 s49, s49, 4096
    buffer_load_dwordx4 a[32:35], v4, s[24:27], s48 offen offset:0
    buffer_load_dwordx4 a[88:91], v4, s[24:27], s49 offen offset:0
    buffer_load_dwordx4 a[36:39], v4, s[24:27], s48 offen offset:1024
    buffer_load_dwordx4 a[92:95], v4, s[24:27], s49 offen offset:1024
    buffer_load_dwordx4 a[40:43], v4, s[24:27], s48 offen offset:2048
    buffer_load_dwordx4 a[96:99], v4, s[24:27], s49 offen offset:2048
    buffer_load_dwordx4 a[44:47], v4, s[24:27], s48 offen offset:3072
    buffer_load_dwordx4 a[100:103], v4, s[24:27], s49 offen offset:3072
    s_add_u32 s48, s48, 4096
    s_add_u32 s49, s49, 4096
    buffer_load_dwordx4 a[48:51], v4, s[24:27], s48 offen offset:0
    buffer_load_dwordx4 a[104:107], v4, s[24:27], s49 offen offset:0
    buffer_load_dwordx4 a[52:55], v4, s[24:27], s48 offen offset:1024
    buffer_load_dwordx4 a[108:111], v4, s[24:27], s49 offen offset:1024
    s_add_u32 m0, s63, 151552
    s_nop 0
    buffer_load_dwordx4 v249, s[16:19], s62 offen lds
    s_add_u32 m0, s63, 152576
    s_nop 0
    buffer_load_dwordx4 v249, s[16:19], s65 offen lds
KB_P4WAIT:
    s_cmp_eq_u32 s50, 0
    s_cbranch_scc0 KB_GOTD
    s_lshl_b32 s69, s75, 7
    s_add_u32 s69, s69, 4096
    v_min_u32 v21, 6, v2
    v_lshlrev_b32 v21, 2, v21
    v_add_u32 v21, s69, v21
    s_mov_b32 s69, 0
KB_POLLD:
    buffer_load_dword v22, v21, s[36:39], 0 offen sc0 sc1
    s_waitcnt vmcnt(0)
    v_cmp_eq_u32 vcc, 0, v22
    s_add_u32 s69, s69, 1
    s_cbranch_vccz KB_GOTD
    s_sleep 4
    s_cmp_lt_u32 s69, 0x40000
    s_cbranch_scc1 KB_POLLD
KB_GOTD:
    s_barrier
    buffer_load_dwordx4 a[112:115], v4, s[20:23], s56 offen offset:0
    buffer_load_dwordx4 a[168:171], v4, s[20:23], s57 offen offset:0
    buffer_load_dwordx4 a[116:119], v4, s[20:23], s56 offen offset:1024
    buffer_load_dwordx4 a[172:175], v4, s[20:23], s57 offen offset:1024
    buffer_load_dwordx4 a[120:123], v4, s[20:23], s56 offen offset:2048
    buffer_load_dwordx4 a[176:179], v4, s[20:23], s57 offen offset:2048
    buffer_load_dwordx4 a[124:127], v4, s[20:23], s56 offen offset:3072
    buffer_load_dwordx4 a[180:183], v4, s[20:23], s57 offen offset:3072
    s_add_u32 s56, s56, 4096
    s_add_u32 s57, s57, 4096
    buffer_load_dwordx4 a[128:131], v4, s[20:23], s56 offen offset:0
    buffer_load_dwordx4 a[184:187], v4, s[20:23], s57 offen offset:0
    buffer_load_dwordx4 a[132:135], v4, s[20:23], s56 offen offset:1024
    buffer_load_dwordx4 a[188:191], v4, s[20:23], s57 offen offset:1024
    buffer_load_dwordx4 a[136:139], v4, s[20:23], s56 offen offset:2048
    buffer_load_dwordx4 a[192:195], v4, s[20:23], s57 offen offset:2048
    buffer_load_dwordx4 a[140:143], v4, s[20:23], s56 offen offset:3072
    buffer_load_dwordx4 a[196:199], v4, s[20:23], s57 offen offset:3072
    s_waitcnt vmcnt(14)
    v_mfma_f32_32x32x16_bf16 v[32:47], a[0:3], a[112:115], 0
    s_add_u32 s56, s56, 4096
    s_add_u32 s57, s57, 4096
    buffer_load_dwordx4 a[144:147], v4, s[20:23], s56 offen offset:0
    v_mfma_f32_32x32x16_bf16 v[48:63], a[0:3], a[168:171], 0
    v_mfma_f32_32x32x16_bf16 v[64:79], a[56:59], a[112:115], 0
    buffer_load_dwordx4 a[200:203], v4, s[20:23], s57 offen offset:0
    v_mfma_f32_32x32x16_bf16 v[80:95], a[56:59], a[168:171], 0
    s_waitcnt vmcnt(14)
    v_mfma_f32_32x32x16_bf16 v[32:47], a[4:7], a[116:119], v[32:47]
    buffer_load_dwordx4 a[148:151], v4, s[20:23], s56 offen offset:1024
    v_mfma_f32_32x32x16_bf16 v[48:63], a[4:7], a[172:175], v[48:63]
    v_mfma_f32_32x32x16_bf16 v[64:79], a[60:63], a[116:119], v[64:79]
    buffer_load_dwordx4 a[204:207], v4, s[20:23], s57 offen offset:1024
    v_mfma_f32_32x32x16_bf16 v[80:95], a[60:63], a[172:175], v[80:95]
    s_waitcnt vmcnt(14)
    v_mfma_f32_32x32x16_bf16 v[32:47], a[8:11], a[120:123], v[32:47]
    buffer_load_dwordx4 a[152:155], v4, s[20:23], s56 offen offset:2048
    v_mfma_f32_32x32x16_bf16 v[48:63], a[8:11], a[176:179], v[48:63]
    v_mfma_f32_32x32x16_bf16 v[64:79], a[64:67], a[120:123], v[64:79]
    buffer_load_dwordx4 a[208:211], v4, s[20:23], s57 offen offset:2048
    v_mfma_f32_32x32x16_bf16 v[80:95], a[64:67], a[176:179], v[80:95]
    s_waitcnt vmcnt(14)
    v_mfma_f32_32x32x16_bf16 v[32:47], a[12:15], a[124:127], v[32:47]
    buffer_load_dwordx4 a[156:159], v4, s[20:23], s56 offen offset:3072
    v_mfma_f32_32x32x16_bf16 v[48:63], a[12:15], a[180:183], v[48:63]
    v_mfma_f32_32x32x16_bf16 v[64:79], a[68:71], a[124:127], v[64:79]
    buffer_load_dwordx4 a[212:215], v4, s[20:23], s57 offen offset:3072
    v_mfma_f32_32x32x16_bf16 v[80:95], a[68:71], a[180:183], v[80:95]
    s_waitcnt vmcnt(14)
    v_mfma_f32_32x32x16_bf16 v[32:47], a[16:19], a[128:131], v[32:47]
    s_add_u32 s56, s56, 4096
    s_add_u32 s57, s57, 4096
    buffer_load_dwordx4 a[160:163], v4, s[20:23], s56 offen offset:0
    v_mfma_f32_32x32x16_bf16 v[48:63], a[16:19], a[184:187], v[48:63]
    v_mfma_f32_32x32x16_bf16 v[64:79], a[72:75], a[128:131], v[64:79]
    buffer_load_dwordx4 a[216:219], v4, s[20:23], s57 offen offset:0
    v_mfma_f32_32x32x16_bf16 v[80:95], a[72:75], a[184:187], v[80:95]
    s_waitcnt vmcnt(14)
    v_mfma_f32_32x32x16_bf16 v[32:47], a[20:23], a[132:135], v[32:47]
    buffer_load_dwordx4 a[164:167], v4, s[20:23], s56 offen offset:1024
    v_mfma_f32_32x32x16_bf16 v[48:63], a[20:23], a[188:191], v[48:63]
    v_mfma_f32_32x32x16_bf16 v[64:79], a[76:79], a[132:135], v[64:79]
    buffer_load_dwordx4 a[220:223], v4, s[20:23], s57 offen offset:1024
    v_mfma_f32_32x32x16_bf16 v[80:95], a[76:79], a[188:191], v[80:95]
    s_waitcnt vmcnt(14)
    v_mfma_f32_32x32x16_bf16 v[32:47], a[24:27], a[136:139], v[32:47]
    v_mfma_f32_32x32x16_bf16 v[48:63], a[24:27], a[192:195], v[48:63]
    v_mfma_f32_32x32x16_bf16 v[64:79], a[80:83], a[136:139], v[64:79]
    v_mfma_f32_32x32x16_bf16 v[80:95], a[80:83], a[192:195], v[80:95]
    s_waitcnt vmcnt(12)
    v_mfma_f32_32x32x16_bf16 v[32:47], a[28:31], a[140:143], v[32:47]
    v_mfma_f32_32x32x16_bf16 v[48:63], a[28:31], a[196:199], v[48:63]
    v_mfma_f32_32x32x16_bf16 v[64:79], a[84:87], a[140:143], v[64:79]
    v_mfma_f32_32x32x16_bf16 v[80:95], a[84:87], a[196:199], v[80:95]
    s_waitcnt vmcnt(10)
    v_mfma_f32_32x32x16_bf16 v[32:47], a[32:35], a[144:147], v[32:47]
    v_mfma_f32_32x32x16_bf16 v[48:63], a[32:35], a[200:203], v[48:63]
    v_mfma_f32_32x32x16_bf16 v[64:79], a[88:91], a[144:147], v[64:79]
    v_mfma_f32_32x32x16_bf16 v[80:95], a[88:91], a[200:203], v[80:95]
    s_waitcnt vmcnt(8)
    v_mfma_f32_32x32x16_bf16 v[32:47], a[36:39], a[148:151], v[32:47]
    v_mfma_f32_32x32x16_bf16 v[48:63], a[36:39], a[204:207], v[48:63]
    v_mfma_f32_32x32x16_bf16 v[64:79], a[92:95], a[148:151], v[64:79]
    v_mfma_f32_32x32x16_bf16 v[80:95], a[92:95], a[204:207], v[80:95]
    s_waitcnt vmcnt(6)
    v_mfma_f32_32x32x16_bf16 v[32:47], a[40:43], a[152:155], v[32:47]
    v_mfma_f32_32x32x16_bf16 v[48:63], a[40:43], a[208:211], v[48:63]
    v_mfma_f32_32x32x16_bf16 v[64:79], a[96:99], a[152:155], v[64:79]
    v_mfma_f32_32x32x16_bf16 v[80:95], a[96:99], a[208:211], v[80:95]
    s_waitcnt vmcnt(4)
    v_mfma_f32_32x32x16_bf16 v[32:47], a[44:47], a[156:159], v[32:47]
    v_mfma_f32_32x32x16_bf16 v[48:63], a[44:47], a[212:215], v[48:63]
    v_mfma_f32_32x32x16_bf16 v[64:79], a[100:103], a[156:159], v[64:79]
    v_mfma_f32_32x32x16_bf16 v[80:95], a[100:103], a[212:215], v[80:95]
    s_waitcnt vmcnt(2)
    v_mfma_f32_32x32x16_bf16 v[32:47], a[48:51], a[160:163], v[32:47]
    v_mfma_f32_32x32x16_bf16 v[48:63], a[48:51], a[216:219], v[48:63]
    v_mfma_f32_32x32x16_bf16 v[64:79], a[104:107], a[160:163], v[64:79]
    v_mfma_f32_32x32x16_bf16 v[80:95], a[104:107], a[216:219], v[80:95]
    s_waitcnt vmcnt(0)
    v_mfma_f32_32x32x16_bf16 v[32:47], a[52:55], a[164:167], v[32:47]
    v_mfma_f32_32x32x16_bf16 v[48:63], a[52:55], a[220:223], v[48:63]
    v_mfma_f32_32x32x16_bf16 v[64:79], a[108:111], a[164:167], v[64:79]
    v_mfma_f32_32x32x16_bf16 v[80:95], a[108:111], a[220:223], v[80:95]
    s_nop 11
    ds_write_b128 v240, v[48:51] offset:0
    ds_write_b128 v240, v[52:55] offset:1024
    ds_write_b128 v240, v[56:59] offset:2048
    ds_write_b128 v240, v[60:63] offset:3072
    ds_write_b128 v241, v[64:67] offset:0
    ds_write_b128 v241, v[68:71] offset:1024
    ds_write_b128 v241, v[72:75] offset:2048
    ds_write_b128 v241, v[76:79] offset:3072
    ds_write_b128 v242, v[80:83] offset:0
    ds_write_b128 v242, v[84:87] offset:1024
    ds_write_b128 v242, v[88:91] offset:2048
    ds_write_b128 v242, v[92:95] offset:3072
    s_waitcnt lgkmcnt(0)
    s_barrier
    ds_read_b128 v[96:99], v243 offset:0
    ds_read_b128 v[100:103], v243 offset:1024
    ds_read_b128 v[104:107], v243 offset:2048
    ds_read_b128 v[108:111], v243 offset:3072
    ds_read_b128 v[112:115], v244 offset:0
    ds_read_b128 v[116:119], v244 offset:1024
    ds_read_b128 v[120:123], v244 offset:2048
    ds_read_b128 v[124:127], v244 offset:3072
    ds_read_b128 v[128:131], v245 offset:0
    ds_read_b128 v[132:135], v245 offset:1024
    ds_read_b128 v[136:139], v245 offset:2048
    ds_read_b128 v[140:143], v245 offset:3072
    ds_read_b64_tr_b16 v[144:145], v246 offset:0
    ds_read_b64_tr_b16 v[146:147], v246 offset:1024
    ds_read_b64_tr_b16 v[148:149], v246 offset:2048
    ds_read_b64_tr_b16 v[150:151], v246 offset:3072
    s_waitcnt lgkmcnt(4)
    v_pk_add_f32 v[96:97], v[96:97], v[112:113]
    v_pk_add_f32 v[32:33], v[32:33], v[128:129]
    v_pk_add_f32 v[98:99], v[98:99], v[114:115]
    v_pk_add_f32 v[34:35], v[34:35], v[130:131]
    v_pk_add_f32 v[100:101], v[100:101], v[116:117]
    v_pk_add_f32 v[36:37], v[36:37], v[132:133]
    v_pk_add_f32 v[102:103], v[102:103], v[118:119]
    v_pk_add_f32 v[38:39], v[38:39], v[134:135]
    v_pk_add_f32 v[104:105], v[104:105], v[120:121]
    v_pk_add_f32 v[40:41], v[40:41], v[136:137]
    v_pk_add_f32 v[106:107], v[106:107], v[122:123]
    v_pk_add_f32 v[42:43], v[42:43], v[138:139]
    v_pk_add_f32 v[108:109], v[108:109], v[124:125]
    v_pk_add_f32 v[44:45], v[44:45], v[140:141]
    v_pk_add_f32 v[110:111], v[110:111], v[126:127]
    v_pk_add_f32 v[46:47], v[46:47], v[142:143]
    v_pk_add_f32 v[32:33], v[32:33], v[96:97]
    v_pk_add_f32 v[34:35], v[34:35], v[98:99]
    v_pk_add_f32 v[36:37], v[36:37], v[100:101]
    v_pk_add_f32 v[38:39], v[38:39], v[102:103]
    v_pk_add_f32 v[40:41], v[40:41], v[104:105]
    v_pk_add_f32 v[42:43], v[42:43], v[106:107]
    v_pk_add_f32 v[44:45], v[44:45], v[108:109]
    v_pk_add_f32 v[46:47], v[46:47], v[110:111]
    s_waitcnt lgkmcnt(0)
    v_lshlrev_b32 v160, 16, v144
    v_and_b32 v161, 0xffff0000, v144
    v_lshlrev_b32 v162, 16, v145
    v_and_b32 v163, 0xffff0000, v145
    v_lshlrev_b32 v164, 16, v146
    v_and_b32 v165, 0xffff0000, v146
    v_lshlrev_b32 v166, 16, v147
    v_and_b32 v167, 0xffff0000, v147
    v_lshlrev_b32 v168, 16, v148
    v_and_b32 v169, 0xffff0000, v148
    v_lshlrev_b32 v170, 16, v149
    v_and_b32 v171, 0xffff0000, v149
    v_lshlrev_b32 v172, 16, v150
    v_and_b32 v173, 0xffff0000, v150
    v_lshlrev_b32 v174, 16, v151
    v_and_b32 v175, 0xffff0000, v151
    v_pk_add_f32 v[32:33], v[32:33], v[160:161]
    v_pk_add_f32 v[34:35], v[34:35], v[162:163]
    v_pk_add_f32 v[36:37], v[36:37], v[164:165]
    v_pk_add_f32 v[38:39], v[38:39], v[166:167]
    v_pk_add_f32 v[40:41], v[40:41], v[168:169]
    v_pk_add_f32 v[42:43], v[42:43], v[170:171]
    v_pk_add_f32 v[44:45], v[44:45], v[172:173]
    v_pk_add_f32 v[46:47], v[46:47], v[174:175]
    v_cvt_pk_bf16_f32 v176, v32, v33
    v_cvt_pk_bf16_f32 v177, v34, v35
    v_cvt_pk_bf16_f32 v178, v36, v37
    v_cvt_pk_bf16_f32 v179, v38, v39
    v_cvt_pk_bf16_f32 v180, v40, v41
    v_cvt_pk_bf16_f32 v181, v42, v43
    v_cvt_pk_bf16_f32 v182, v44, v45
    v_cvt_pk_bf16_f32 v183, v46, v47
    s_nop 1
    v_permlane32_swap_b32 v176, v178
    v_permlane32_swap_b32 v177, v179
    v_permlane32_swap_b32 v180, v182
    v_permlane32_swap_b32 v181, v183
    s_nop 1
    buffer_store_dwordx4 v[176:179], v247, s[28:31], 0 offen
    buffer_store_dwordx4 v[180:183], v247, s[28:31], 0 offen offset:32
    s_endpgm
KB_HELP:
    s_sub_u32 s52, s71, 28
    s_lshl_b32 s52, s52, 2
    s_add_u32 s52, s52, s50
    s_getpc_b64 s[80:81]
KBT_PC:
    s_sub_u32 s80, s80, KBT_PC-kb_kernel
    s_subb_u32 s81, s81, 0
    s_lshl_b32 s82, s52, 13
    v_lshlrev_b32 v12, 7, v2
    v_add_u32 v12, s82, v12
    s_mov_b32 s82, KB_CODE_END-kb_kernel-4
    v_min_u32 v12, s82, v12
    global_load_dword v13, v12, s[80:81]
    s_lshr_b32 s53, s52, 2
    s_add_u32 s54, s53, s77
    s_cmp_lt_u32 s53, 3
    s_cselect_b32 s54, s54, 3
    s_lshl_b32 s55, s54, 2
    s_and_b32 s56, s52, 3
    s_add_u32 s55, s55, s56
    v_lshlrev_b32 v3, 7, v2
    s_add_u32 s16, s12, 8388608
    s_addc_u32 s17, s13, 0
    s_mov_b32 s18, 1835008
    s_mov_b32 s19, 0x00020000
    s_add_u32 s57, s55, 28
    s_lshl_b32 s57, s57, 15
    s_add_u32 s20, s12, 5242880
    s_addc_u32 s21, s13, 0
    s_mov_b32 s22, 2162688
    s_mov_b32 s23, 0x00020000
    s_and_b32 s58, s52, 7
    s_add_u32 s58, s58, s72
    s_lshl_b32 s58, s58, 7
    s_lshr_b32 s59, s52, 3
    s_lshl_b32 s59, s59, 2
    s_and_b32 s60, s70, 7
    s_add_u32 s59, s59, s60
    s_lshl_b32 s60, s60, 12
    v_mul_u32_u24 v8, 4224, v2
    s_and_b32 s61, s59, 7
    s_mul_i32 s61, s61, 270336
    s_add_u32 s61, s61, s58
    buffer_load_dword v7, v8, s[20:23], s61 offen
    s_add_u32 s59, s59, 1
    s_and_b32 s61, s60, 32767
    s_add_u32 s61, s61, s57
    buffer_load_dword v7, v3, s[16:19], s61 offen
    s_add_u32 s60, s60, 8192
    s_and_b32 s61, s59, 7
    s_mul_i32 s61, s61, 270336
    s_add_u32 s61, s61, s58
    buffer_load_dword v7, v8, s[20:23], s61 offen
    s_add_u32 s59, s59, 1
    s_and_b32 s61, s60, 32767
    s_add_u32 s61, s61, s57
    buffer_load_dword v7, v3, s[16:19], s61 offen
    s_add_u32 s60, s60, 8192
    s_and_b32 s61, s59, 7
    s_mul_i32 s61, s61, 270336
    s_add_u32 s61, s61, s58
    buffer_load_dword v7, v8, s[20:23], s61 offen
    s_add_u32 s59, s59, 1
    s_and_b32 s61, s60, 32767
    s_add_u32 s61, s61, s57
    buffer_load_dword v7, v3, s[16:19], s61 offen
    s_add_u32 s60, s60, 8192
    s_and_b32 s61, s59, 7
    s_mul_i32 s61, s61, 270336
    s_add_u32 s61, s61, s58
    buffer_load_dword v7, v8, s[20:23], s61 offen
    s_add_u32 s59, s59, 1
    s_and_b32 s61, s60, 32767
    s_add_u32 s61, s61, s57
    buffer_load_dword v7, v3, s[16:19], s61 offen
    s_add_u32 s60, s60, 8192
    s_lshl_b32 s57, s55, 15
    buffer_load_dword v7, v3, s[16:19], s57 offen
    s_add_u32 s57, s57, 8192
    buffer_load_dword v7, v3, s[16:19], s57 offen
    s_add_u32 s57, s57, 8192
    buffer_load_dword v7, v3, s[16:19], s57 offen
    s_add_u32 s57, s57, 8192
    buffer_load_dword v7, v3, s[16:19], s57 offen
    s_add_u32 s57, s57, 8192
    s_lshl_b32 s57, s72, 18
    s_lshl_b32 s58, s52, 17
    s_add_u32 s57, s57, s58
    s_add_u32 s20, s4, s57
    s_addc_u32 s21, s5, 0
    s_mov_b32 s22, 131072
    s_mov_b32 s23, 0x00020000
    v_and_b32 v8, 31, v2
    v_lshlrev_b32 v8, 12, v8
    v_lshrrev_b32 v11, 5, v2
    v_lshlrev_b32 v11, 11, v11
    v_add_u32 v8, v8, v11
    s_mov_b32 s57, 0
    buffer_load_dword v7, v8, s[20:23], s57 offen
    s_add_u32 s57, s57, 128
    buffer_load_dword v7, v8, s[20:23], s57 offen
    s_add_u32 s57, s57, 128
    buffer_load_dword v7, v8, s[20:23], s57 offen
    s_add_u32 s57, s57, 128
    buffer_load_dword v7, v8, s[20:23], s57 offen
    s_add_u32 s57, s57, 128
    buffer_load_dword v7, v8, s[20:23], s57 offen
    s_add_u32 s57, s57, 128
    buffer_load_dword v7, v8, s[20:23], s57 offen
    s_add_u32 s57, s57, 128
    buffer_load_dword v7, v8, s[20:23], s57 offen
    s_add_u32 s57, s57, 128
    buffer_load_dword v7, v8, s[20:23], s57 offen
    s_add_u32 s57, s57, 128
    buffer_load_dword v7, v8, s[20:23], s57 offen
    s_add_u32 s57, s57, 128
    buffer_load_dword v7, v8, s[20:23], s57 offen
    s_add_u32 s57, s57, 128
    buffer_load_dword v7, v8, s[20:23], s57 offen
    s_add_u32 s57, s57, 128
    buffer_load_dword v7, v8, s[20:23], s57 offen
    s_add_u32 s57, s57, 128
    buffer_load_dword v7, v8, s[20:23], s57 offen
    s_add_u32 s57, s57, 128
    buffer_load_dword v7, v8, s[20:23], s57 offen
    s_add_u32 s57, s57, 128
    buffer_load_dword v7, v8, s[20:23], s57 offen
    s_add_u32 s57, s57, 128
    buffer_load_dword v7, v8, s[20:23], s57 offen
    s_add_u32 s57, s57, 128
    s_add_u32 s24, s12, 10485760
    s_addc_u32 s25, s13, 0
    s_mov_b32 s26, 917504
    s_mov_b32 s27, 0x00020000
    s_mul_i32 s57, s77, 114688
    s_mul_i32 s58, s52, 28672
    s_add_u32 s57, s57, s58
    buffer_load_dword v7, v3, s[24:27], s57 offen
    s_add_u32 s57, s57, 8192
    buffer_load_dword v7, v3, s[24:27], s57 offen
    s_add_u32 s57, s57, 8192
    buffer_load_dword v7, v3, s[24:27], s57 offen
    s_add_u32 s57, s57, 8192
    buffer_load_dword v7, v3, s[24:27], s57 offen
    s_add_u32 s57, s57, 8192
    s_lshl_b32 s57, s54, 7
    v_lshlrev_b32 v8, 2, v5
    v_add_u32 v8, s57, v8
    s_mov_b32 s58, 0
KB_HPOLL:
    buffer_load_dword v11, v8, s[36:39], 0 offen sc0 sc1
    s_waitcnt vmcnt(0)
    v_cmp_eq_u32 vcc, 0, v11
    s_add_u32 s58, s58, 1
    s_cbranch_vccz KB_HGOT
    s_sleep 8
    s_cmp_lt_u32 s58, 0x40000
    s_cbranch_scc1 KB_HPOLL
KB_HGOT:
    s_lshl_b32 s57, s55, 17
    s_add_u32 s40, s12, 15728640
    s_addc_u32 s41, s13, 0
    s_add_u32 s40, s40, s57
    s_addc_u32 s41, s41, 0
    s_mov_b32 s42, 131072
    s_mov_b32 s43, 0x00020000
    s_mov_b32 s57, 0
    buffer_load_dword v7, v3, s[40:43], s57 offen
    s_add_u32 s58, s57, 65536
    buffer_load_dword v7, v3, s[40:43], s58 offen
    s_add_u32 s57, s57, 8192
    buffer_load_dword v7, v3, s[40:43], s57 offen
    s_add_u32 s58, s57, 65536
    buffer_load_dword v7, v3, s[40:43], s58 offen
    s_add_u32 s57, s57, 8192
    buffer_load_dword v7, v3, s[40:43], s57 offen
    s_add_u32 s58, s57, 65536
    buffer_load_dword v7, v3, s[40:43], s58 offen
    s_add_u32 s57, s57, 8192
    buffer_load_dword v7, v3, s[40:43], s57 offen
    s_add_u32 s58, s57, 65536
    buffer_load_dword v7, v3, s[40:43], s58 offen
    s_add_u32 s57, s57, 8192
    buffer_load_dword v7, v3, s[40:43], s57 offen
    s_add_u32 s58, s57, 65536
    buffer_load_dword v7, v3, s[40:43], s58 offen
    s_add_u32 s57, s57, 8192
    buffer_load_dword v7, v3, s[40:43], s57 offen
    s_add_u32 s58, s57, 65536
    buffer_load_dword v7, v3, s[40:43], s58 offen
    s_add_u32 s57, s57, 8192
    buffer_load_dword v7, v3, s[40:43], s57 offen
    s_add_u32 s58, s57, 65536
    buffer_load_dword v7, v3, s[40:43], s58 offen
    s_add_u32 s57, s57, 8192
    buffer_load_dword v7, v3, s[40:43], s57 offen
    s_add_u32 s58, s57, 65536
    buffer_load_dword v7, v3, s[40:43], s58 offen
    s_add_u32 s57, s57, 8192
    s_lshr_b32 s53, s50, 1
    s_and_b32 s54, s50, 1
    s_mul_i32 s55, s50, 14336
    s_lshl_b32 s56, s76, 1
    s_add_u32 s48, s56, s53
    s_xor_b32 s49, s53, 1
    s_add_u32 s49, s56, s49
    s_lshl_b32 s57, s75, 1
    s_add_u32 s56, s57, s54
    s_xor_b32 s82, s54, 1
    s_add_u32 s57, s57, s82
    s_mul_i32 s48, s48, 57344
    s_add_u32 s48, s48, s55
    s_mul_i32 s49, s49, 57344
    s_add_u32 s49, s49, s55
    s_mul_i32 s56, s56, 57344
    s_add_u32 s56, s56, s55
    s_mul_i32 s57, s57, 57344
    s_add_u32 s57, s57, s55
    s_add_u32 s24, s12, 10485760
    s_addc_u32 s25, s13, 0
    s_mov_b32 s26, 917504
    s_mov_b32 s27, 0x00020000
    s_mul_i32 s80, s76, 270336
    s_lshl_b32 s81, s75, 7
    s_add_u32 s80, s80, s81
    s_add_u32 s20, s12, 19922944
    s_addc_u32 s21, s13, 0
    s_mov_b32 s22, 3670016
    s_mov_b32 s23, 0x00020000
    s_add_u32 s16, s12, 5242880
    s_addc_u32 s17, s13, 0
    s_add_u32 s16, s16, s80
    s_addc_u32 s17, s17, 0
    s_mov_b32 s18, 266240
    s_mov_b32 s19, 0x00020000
    s_mov_b32 s28, s8
    s_mov_b32 s29, s9
    s_mov_b32 s30, 2097152
    s_mov_b32 s31, 0x00020000
    v_lshrrev_b32 v249, 3, v2
    v_mul_u32_u24 v249, 4224, v249
    v_and_b32 v250, 7, v2
    v_and_b32 v251, 1, v9
    v_lshlrev_b32 v251, 2, v251
    v_xor_b32 v250, v250, v251
    v_lshlrev_b32 v250, 4, v250
    v_add_u32 v249, v249, v250
    s_mul_i32 s62, s50, 67584
    s_lshl_b32 s63, s50, 11
    s_add_u32 s65, s62, 33792
    s_add_u32 m0, s63, 151552
    s_nop 0
    buffer_load_dwordx4 v249, s[16:19], s62 offen lds
    s_add_u32 m0, s63, 152576
    s_nop 0
    buffer_load_dwordx4 v249, s[16:19], s65 offen lds
    s_lshl_b32 s78, s50, 12
    s_xor_b32 s79, s50, 1
    s_lshl_b32 s79, s79, 14
    s_add_u32 s79, s79, s78
    v_add_u32 v240, s79, v4
    s_xor_b32 s79, s50, 1
    s_lshl_b32 s79, s79, 12
    s_lshl_b32 s69, s50, 14
    s_add_u32 s79, s79, s69
    v_add_u32 v243, s79, v4
    s_xor_b32 s79, s50, 2
    s_lshl_b32 s79, s79, 14
    s_add_u32 s79, s79, s78
    v_add_u32 v241, s79, v4
    s_xor_b32 s79, s50, 2
    s_lshl_b32 s79, s79, 12
    s_lshl_b32 s69, s50, 14
    s_add_u32 s79, s79, s69
    v_add_u32 v244, s79, v4
    s_xor_b32 s79, s50, 3
    s_lshl_b32 s79, s79, 14
    s_add_u32 s79, s79, s78
    v_add_u32 v242, s79, v4
    s_xor_b32 s79, s50, 3
    s_lshl_b32 s79, s79, 12
    s_lshl_b32 s69, s50, 14
    s_add_u32 s79, s79, s69
    v_add_u32 v245, s79, v4
    v_lshrrev_b32 v246, 1, v9
    v_lshlrev_b32 v246, 2, v246
    v_lshrrev_b32 v247, 2, v10
    v_add_u32 v246, v246, v247
    s_lshl_b32 s69, s53, 5
    v_add_u32 v246, s69, v246
    v_lshlrev_b32 v246, 7, v246
    v_and_b32 v247, 1, v9
    v_lshlrev_b32 v247, 5, v247
    v_and_b32 v248, 3, v10
    v_lshlrev_b32 v248, 3, v248
    v_add3_u32 v246, v246, v247, v248
    v_lshrrev_b32 v247, 3, v10
    v_xor_b32 v247, s54, v247
    v_lshlrev_b32 v247, 6, v247
    v_add_u32 v246, v246, v247
    v_add_u32 v246, 151552, v246
    s_lshl_b32 s69, s75, 6
    s_lshl_b32 s80, s54, 5
    s_add_u32 s69, s69, s80
    v_add_u32 v247, s69, v5
    v_lshlrev_b32 v247, 10, v247
    v_lshlrev_b32 v248, 4, v6
    s_lshl_b32 s69, s76, 7
    s_lshl_b32 s80, s53, 6
    s_add_u32 s69, s69, s80
    v_add3_u32 v247, v247, v248, s69
    buffer_load_dwordx4 a[0:3], v4, s[24:27], s48 offen offset:0
    buffer_load_dwordx4 a[56:59], v4, s[24:27], s49 offen offset:0
    buffer_load_dwordx4 a[4:7], v4, s[24:27], s48 offen offset:1024
    buffer_load_dwordx4 a[60:63], v4, s[24:27], s49 offen offset:1024
    buffer_load_dwordx4 a[8:11], v4, s[24:27], s48 offen offset:2048
    buffer_load_dwordx4 a[64:67], v4, s[24:27], s49 offen offset:2048
    buffer_load_dwordx4 a[12:15], v4, s[24:27], s48 offen offset:3072
    buffer_load_dwordx4 a[68:71], v4, s[24:27], s49 offen offset:3072
    s_add_u32 s48, s48, 4096
    s_add_u32 s49, s49, 4096
    buffer_load_dwordx4 a[16:19], v4, s[24:27], s48 offen offset:0
    buffer_load_dwordx4 a[72:75], v4, s[24:27], s49 offen offset:0
    buffer_load_dwordx4 a[20:23], v4, s[24:27], s48 offen offset:1024
    buffer_load_dwordx4 a[76:79], v4, s[24:27], s49 offen offset:1024
    buffer_load_dwordx4 a[24:27], v4, s[24:27], s48 offen offset:2048
    buffer_load_dwordx4 a[80:83], v4, s[24:27], s49 offen offset:2048
    buffer_load_dwordx4 a[28:31], v4, s[24:27], s48 offen offset:3072
    buffer_load_dwordx4 a[84:87], v4, s[24:27], s49 offen offset:3072
    s_add_u32 s48, s48, 4096
    s_add_u32 s49, s49, 4096
    buffer_load_dwordx4 a[32:35], v4, s[24:27], s48 offen offset:0
    buffer_load_dwordx4 a[88:91], v4, s[24:27], s49 offen offset:0
    buffer_load_dwordx4 a[36:39], v4, s[24:27], s48 offen offset:1024
    buffer_load_dwordx4 a[92:95], v4, s[24:27], s49 offen offset:1024
    buffer_load_dwordx4 a[40:43], v4, s[24:27], s48 offen offset:2048
    buffer_load_dwordx4 a[96:99], v4, s[24:27], s49 offen offset:2048
    buffer_load_dwordx4 a[44:47], v4, s[24:27], s48 offen offset:3072
    buffer_load_dwordx4 a[100:103], v4, s[24:27], s49 offen offset:3072
    s_add_u32 s48, s48, 4096
    s_add_u32 s49, s49, 4096
    buffer_load_dwordx4 a[48:51], v4, s[24:27], s48 offen offset:0
    buffer_load_dwordx4 a[104:107], v4, s[24:27], s49 offen offset:0
    buffer_load_dwordx4 a[52:55], v4, s[24:27], s48 offen offset:1024
    buffer_load_dwordx4 a[108:111], v4, s[24:27], s49 offen offset:1024
    s_branch KB_P4WAIT
KB_END:
    s_endpgm
KB_CODE_END:
.section .rodata,"a"
.p2align 6
.amdhsa_kernel ka_kernel
  .amdhsa_next_free_vgpr 240
  .amdhsa_next_free_sgpr 102
  .amdhsa_accum_offset 240
  .amdhsa_group_segment_fixed_size 0
  .amdhsa_kernarg_size 112
  .amdhsa_user_sgpr_count 2
  .amdhsa_user_sgpr_kernarg_segment_ptr 1
  .amdhsa_system_sgpr_workgroup_id_x 1
  .amdhsa_float_denorm_mode_32 3
.end_amdhsa_kernel
.p2align 6
.amdhsa_kernel kb_kernel
  .amdhsa_next_free_vgpr 512
  .amdhsa_next_free_sgpr 102
  .amdhsa_accum_offset 256
  .amdhsa_group_segment_fixed_size 0
  .amdhsa_kernarg_size 112
  .amdhsa_user_sgpr_count 2
  .amdhsa_user_sgpr_kernarg_segment_ptr 1
  .amdhsa_system_sgpr_workgroup_id_x 1
  .amdhsa_float_denorm_mode_32 3
.end_amdhsa_kernel
```
